```python
import torch

def _softmax(x, axis=-1):
    return torch.softmax(x, dim=axis)
def _gelu(x):
    return torch.nn.functional.gelu(x, approximate="tanh")
def _silu(x):
    return torch.nn.functional.silu(x)
def _sigmoid(x):
    return torch.sigmoid(x)
def _layernorm(x, axis=-1, eps=1e-5):
    m = x.mean(dim=axis, keepdim=True)
    v = x.var(dim=axis, keepdim=True, unbiased=False)
    return (x - m) / torch.sqrt(v + eps)
def _scatter_add(tgt, idx, src, axis=0):
    return tgt.clone().index_add_(axis, idx, src)
def _segment_sum(src, seg, n):
    out = torch.zeros((n,) + src.shape[1:], dtype=src.dtype)
    return out.index_add_(0, seg, src)
def _pad(x, pw):
    flat = tuple(v for pair in reversed(pw) for v in pair)
    return torch.nn.functional.pad(x, flat)

kernel_name = 'sequential_preLN__sliding_block__dense_activation_squared_relu__prompt'

def setup_inputs():

    _w = (lambda a: (lambda t: t.to(torch.bfloat16) if t.is_floating_point() else t)(torch.as_tensor(a)))
    def _A_setup():
        B, S, D = 1, 2048, 448
        return {
            "x": _w((lambda *s: torch.randn(*s, dtype=torch.bfloat16) * 0.05)(B, S, D)),
            "wqkv": _w((lambda *s: torch.randn(*s, dtype=torch.bfloat16) * 0.05)(D, 3 * D)),
            "wo": _w((lambda *s: torch.randn(*s, dtype=torch.bfloat16) * 0.05)(D, D)),
        }
    _A_in = _A_setup()

    def _B_setup():
        B, S, D, F = 1, 2048, 448, 1792
        return {
            "x": _w((lambda *s: torch.randn(*s, dtype=torch.bfloat16) * 0.05)(B, S, D)),
            "w1": _w((lambda *s: torch.randn(*s, dtype=torch.bfloat16) * 0.05)(D, F)),
            "b1": _w((lambda *s: torch.randn(*s, dtype=torch.bfloat16) * 0.4)(F)),
            "w2": _w((lambda *s: torch.randn(*s, dtype=torch.bfloat16) * 0.05)(F, D)),
            "b2": _w((lambda *s: torch.randn(*s, dtype=torch.bfloat16) * 1.6)(D)),
        }
    _B_in = _B_setup()

    return {
        "A_x": _A_in["x"],
        "A_wqkv": _A_in["wqkv"],
        "A_wo": _A_in["wo"],
        "B_x": _B_in["x"],
        "B_w1": _B_in["w1"],
        "B_b1": _B_in["b1"],
        "B_w2": _B_in["w2"],
        "B_b2": _B_in["b2"],
    }

def reference(A_x, A_wqkv, A_wo, B_x, B_w1, B_b1, B_w2, B_b2):
    def _A_ref(x, wqkv, wo):
        B, S, D = x.shape
        H = 16; Dh = D // H; W = 256
        qkv = (lambda x, *d: x.permute(*d))((x @ wqkv).reshape(B, S, 3, H, Dh), 2, 0, 3, 1, 4)
        q, k, v = qkv[0], qkv[1], qkv[2]
        scores = torch.einsum("bhqd,bhkd->bhqk", q, k) * (Dh ** -0.5)
        idx = torch.arange(S)
        mask = (idx[:, None] - idx[None, :] >= 0) & (idx[:, None] - idx[None, :] < W)
        scores = torch.where(mask[None, None], scores, -1e9)
        p = _softmax(scores, axis=-1)
        o = torch.einsum("bhqk,bhkd->bhqd", p, v)
        return (lambda x, *d: x.permute(*d))(o, 0, 2, 1, 3).reshape(B, S, D) @ wo

    def _B_ref(x, w1, b1, w2, b2):
        h = torch.einsum("bsd,df->bsf", x, w1) + b1
        zero = torch.zeros_like(h)
        r = torch.where(h > zero, h, zero)
        h = r * r
        out = torch.einsum("bsf,fd->bsd", h, w2) + b2
        return out

    x = A_x
    h = x + _A_ref(_layernorm(x, axis=-1), A_wqkv, A_wo)
    h2 = h + _B_ref(_layernorm(h, axis=-1), B_w1, B_b1, B_w2, B_b2)
    return h2
```

```asm
; @launch grid=(256,1,1) block=(512,1,1) lds=156160
.amdgcn_target "amdgcn-amd-amdhsa--gfx950"
.text
.globl sequential_preLN__sliding_block__dense_activation_squared_relu__prompt_kernel
.p2align 8
.type sequential_preLN__sliding_block__dense_activation_squared_relu__prompt_kernel,@function
sequential_preLN__sliding_block__dense_activation_squared_relu__prompt_kernel:
s_cmp_ge_u32 s2, 256
s_cbranch_scc1 K_END
s_load_dwordx4 s[4:7], s[0:1], 0
s_load_dwordx2 s[8:9], s[0:1], 80
s_load_dwordx2 s[10:11], s[0:1], 72
s_load_dwordx2 s[30:31], s[0:1], 16
s_load_dwordx2 s[32:33], s[0:1], 32
s_load_dwordx2 s[34:35], s[0:1], 48
s_load_dwordx2 s[60:61], s[0:1], 40
s_load_dwordx2 s[62:63], s[0:1], 56
s_load_dwordx2 s[96:97], s[0:1], 64
s_getpc_b64 s[44:45]
CODE_HERE:
s_sub_u32 s44, s44, CODE_HERE-sequential_preLN__sliding_block__dense_activation_squared_relu__prompt_kernel
s_subb_u32 s45, s45, 0
s_lshr_b32 s46, s2, 3
s_lshl_b32 s46, s46, 10
v_lshlrev_b32 v9, 4, v0
v_add_u32 v9, s46, v9
v_min_u32 v9, K_CODE_END-sequential_preLN__sliding_block__dense_activation_squared_relu__prompt_kernel-16, v9
v_mov_b32 v124, 0
v_mov_b32 v125, 0
v_mov_b32 v126, 0
v_cmp_gt_u32 vcc, 64, v0
s_and_saveexec_b64 s[46:47], vcc
s_cbranch_execz CODE_SKIP
global_load_dwordx4 v[252:255], v9, s[44:45]
CODE_SKIP:
s_mov_b64 exec, -1
s_and_b32 s24, s2, 7
s_lshl_b32 s24, s24, 2
s_lshr_b32 s26, s2, 6
s_add_u32 s24, s24, s26
s_lshr_b32 s25, s2, 3
s_and_b32 s25, s25, 7
v_and_b32 v1, 63, v0
v_lshrrev_b32 v9, 6, v0
v_and_b32 v2, 15, v1
v_readfirstlane_b32 s26, v9
v_lshrrev_b32 v3, 4, v1
v_lshlrev_b32 v4, 4, v1
s_waitcnt lgkmcnt(0)
s_mov_b32 s20, s8
s_and_b32 s21, s9, 0xffff
s_mov_b32 s22, 33554432
s_mov_b32 s23, 0x00020000
s_mov_b32 s8, s10
s_and_b32 s9, s11, 0xffff
s_mov_b32 s10, 256
s_mov_b32 s11, 0x00020000
s_getreg_b32 s99, hwreg(HW_REG_XCC_ID)
s_and_b32 s99, s99, 0xf
s_mov_b32 s93, 0
s_cmp_lg_u32 s2, 0
s_cbranch_scc1 NP_DONE
s_cmp_lg_u32 s26, 0
s_cbranch_scc1 NP_DONE
s_memrealtime s[58:59]
s_waitcnt lgkmcnt(0)
s_or_b32 s59, s59, 0x80000000
v_mov_b32 v6, s58
v_mov_b32 v7, s59
s_mov_b64 exec, 1
buffer_store_dwordx2 v[6:7], v126, s[8:11], 0 offen sc1
s_mov_b64 exec, -1
NP_DONE:
s_cmp_eq_u32 s25, 7
s_cbranch_scc1 K_RELAYOUT
s_mov_b32 s12, s4
s_and_b32 s13, s5, 0xffff
s_mov_b32 s14, 1835008
s_mov_b32 s15, 0x00020000
s_mov_b32 s16, s6
s_and_b32 s17, s7, 0xffff
s_mov_b32 s18, 1204224
s_mov_b32 s19, 0x00020000
s_lshr_b32 s27, s26, 2
s_and_b32 s28, s26, 3
v_lshrrev_b32 v9, 3, v1
v_and_b32 v10, 7, v1
v_xor_b32 v11, v10, v9
v_lshlrev_b32 v11, 4, v11
v_mul_u32_u24 v4, 896, v9
v_add_u32 v4, v4, v11
v_bfe_u32 v11, v9, 1, 1
s_and_b32 s29, s26, 1
s_lshl_b32 s29, s29, 1
v_or_b32 v11, s29, v11
v_lshlrev_b32 v11, 1, v11
v_xor_b32 v11, v10, v11
v_lshlrev_b32 v11, 4, v11
v_mul_u32_u24 v5, 2688, v9
v_add_u32 v5, v5, v11
s_lshl_b32 s36, s24, 6
s_lshl_b32 s38, s26, 3
s_add_u32 s36, s36, s38
s_mul_i32 s36, s36, 896
s_mul_i32 s37, s38, 2688
s_lshl_b32 s39, s25, 7
s_add_u32 s37, s37, s39
s_lshl_b32 s40, s26, 10
s_lshr_b32 s30, s2, 6
s_lshl_b32 s30, s30, 1
s_add_u32 s30, s30, s25
s_cmp_ge_u32 s30, 7
s_cselect_b32 s31, 7, 0
s_sub_u32 s30, s30, s31
s_cmp_ge_u32 s30, 7
s_cselect_b32 s31, 7, 0
s_sub_u32 s30, s30, s31
s_add_u32 s32, s30, 0
s_cmp_ge_u32 s32, 7
s_cselect_b32 s31, 7, 0
s_sub_u32 s32, s32, s31
s_lshl_b32 s33, s32, 7
s_add_u32 s80, s36, s33
s_mul_i32 s33, s32, 172032
s_add_u32 s87, s33, s37
s_add_u32 m0, s40, 57344
s_add_u32 s41, s87, 0
buffer_load_dwordx4 v5, s[16:19], s41 offen lds
s_add_u32 m0, s40, 65536
s_add_u32 s41, s87, 896
buffer_load_dwordx4 v5, s[16:19], s41 offen lds
s_add_u32 m0, s40, 73728
s_add_u32 s41, s87, 1792
buffer_load_dwordx4 v5, s[16:19], s41 offen lds
s_add_u32 m0, s40, 0
s_nop 0
buffer_load_dwordx4 v4, s[12:15], s80 offen lds
s_add_u32 s32, s30, 1
s_cmp_ge_u32 s32, 7
s_cselect_b32 s31, 7, 0
s_sub_u32 s32, s32, s31
s_lshl_b32 s33, s32, 7
s_add_u32 s81, s36, s33
s_mul_i32 s33, s32, 172032
s_add_u32 s88, s33, s37
s_barrier
s_add_u32 m0, s40, 81920
s_add_u32 s41, s88, 0
buffer_load_dwordx4 v5, s[16:19], s41 offen lds
s_add_u32 m0, s40, 90112
s_add_u32 s41, s88, 896
buffer_load_dwordx4 v5, s[16:19], s41 offen lds
s_add_u32 m0, s40, 98304
s_add_u32 s41, s88, 1792
buffer_load_dwordx4 v5, s[16:19], s41 offen lds
s_add_u32 m0, s40, 8192
s_nop 0
buffer_load_dwordx4 v4, s[12:15], s81 offen lds
s_add_u32 s32, s30, 2
s_cmp_ge_u32 s32, 7
s_cselect_b32 s31, 7, 0
s_sub_u32 s32, s32, s31
s_lshl_b32 s33, s32, 7
s_add_u32 s82, s36, s33
s_mul_i32 s33, s32, 172032
s_add_u32 s89, s33, s37
s_add_u32 s32, s30, 3
s_cmp_ge_u32 s32, 7
s_cselect_b32 s31, 7, 0
s_sub_u32 s32, s32, s31
s_lshl_b32 s33, s32, 7
s_add_u32 s83, s36, s33
s_mul_i32 s33, s32, 172032
s_add_u32 s90, s33, s37
s_add_u32 s32, s30, 4
s_cmp_ge_u32 s32, 7
s_cselect_b32 s31, 7, 0
s_sub_u32 s32, s32, s31
s_lshl_b32 s33, s32, 7
s_add_u32 s84, s36, s33
s_mul_i32 s33, s32, 172032
s_add_u32 s91, s33, s37
s_add_u32 s32, s30, 5
s_cmp_ge_u32 s32, 7
s_cselect_b32 s31, 7, 0
s_sub_u32 s32, s32, s31
s_lshl_b32 s33, s32, 7
s_add_u32 s85, s36, s33
s_mul_i32 s33, s32, 172032
s_add_u32 s92, s33, s37
s_add_u32 s32, s30, 6
s_cmp_ge_u32 s32, 7
s_cselect_b32 s31, 7, 0
s_sub_u32 s32, s32, s31
s_lshl_b32 s33, s32, 7
s_add_u32 s86, s36, s33
s_mul_i32 s33, s32, 172032
s_add_u32 s93, s33, s37
s_barrier
v_and_b32 v9, 7, v2
v_xor_b32 v9, v9, v3
v_lshlrev_b32 v9, 4, v9
s_lshl_b32 s41, s27, 5
v_add_u32 v10, s41, v2
v_lshlrev_b32 v10, 7, v10
v_add_u32 v6, v10, v9
v_xor_b32 v7, 64, v6
v_lshrrev_b32 v9, 2, v2
v_and_b32 v10, 3, v2
v_bfe_u32 v11, v9, 1, 1
v_and_b32 v8, 1, v3
v_lshlrev_b32 v8, 1, v8
v_or_b32 v11, v11, v8
v_lshlrev_b32 v11, 1, v11
v_lshrrev_b32 v8, 1, v10
s_lshl_b32 s41, s28, 1
v_add_u32 v8, s41, v8
v_xor_b32 v8, v8, v11
v_lshlrev_b32 v8, 4, v8
v_and_b32 v10, 1, v10
v_lshlrev_b32 v10, 3, v10
v_add_u32 v8, v8, v10
v_lshlrev_b32 v10, 3, v3
v_add_u32 v10, v10, v9
v_lshlrev_b32 v10, 7, v10
v_add_u32 v8, v8, v10
v_add_u32 v8, 57344, v8
v_mov_b32 v12, 0x3f803f80
v_mov_b32 v13, 0x3f803f80
v_mov_b32 v14, 0x3f803f80
v_mov_b32 v15, 0x3f803f80
v_mov_b32 v128, 0
v_mov_b32 v129, 0
v_mov_b32 v130, 0
v_mov_b32 v131, 0
v_mov_b32 v132, 0
v_mov_b32 v133, 0
v_mov_b32 v134, 0
v_mov_b32 v135, 0
v_mov_b32 v136, 0
v_mov_b32 v137, 0
v_mov_b32 v138, 0
v_mov_b32 v139, 0
v_mov_b32 v140, 0
v_mov_b32 v141, 0
v_mov_b32 v142, 0
v_mov_b32 v143, 0
v_mov_b32 v144, 0
v_mov_b32 v145, 0
v_mov_b32 v146, 0
v_mov_b32 v147, 0
v_mov_b32 v148, 0
v_mov_b32 v149, 0
v_mov_b32 v150, 0
v_mov_b32 v151, 0
v_mov_b32 v152, 0
v_mov_b32 v153, 0
v_mov_b32 v154, 0
v_mov_b32 v155, 0
v_mov_b32 v156, 0
v_mov_b32 v157, 0
v_mov_b32 v158, 0
v_mov_b32 v159, 0
v_mov_b32 v160, 0
v_mov_b32 v161, 0
v_mov_b32 v162, 0
v_mov_b32 v163, 0
v_add_u32 v120, 0, v8
v_add_u32 v121, 24576, v8
v_add_u32 v122, 49152, v8
v_add_u32 v123, 73728, v8
v_lshlrev_b32 v96, 3, v1
s_lshl_b32 s41, s24, 2
s_lshl_b32 s42, s27, 1
s_add_u32 s41, s41, s42
s_mul_i32 s41, s41, 14336
s_lshl_b32 s42, s25, 11
s_add_u32 s41, s41, s42
s_lshl_b32 s42, s28, 9
s_add_u32 s41, s41, s42
s_add_u32 s42, s41, 1048576
s_add_u32 s43, s41, 3145728
v_mul_u32_u24 v16, 7168, v3
v_lshlrev_b32 v17, 4, v2
v_add_u32 v97, v16, v17
s_lshl_b32 s44, s24, 1
s_add_u32 s44, s44, s27
s_mul_i32 s44, s44, 28672
s_lshl_b32 s45, s25, 10
s_add_u32 s44, s44, s45
s_lshl_b32 s45, s28, 8
s_add_u32 s44, s44, s45
s_add_u32 s44, s44, 5242880
s_add_u32 m0, s40, 106496
s_add_u32 s41, s89, 0
buffer_load_dwordx4 v5, s[16:19], s41 offen lds
s_add_u32 m0, s40, 114688
s_add_u32 s41, s89, 896
buffer_load_dwordx4 v5, s[16:19], s41 offen lds
s_add_u32 m0, s40, 122880
s_add_u32 s41, s89, 1792
buffer_load_dwordx4 v5, s[16:19], s41 offen lds
s_add_u32 m0, s40, 16384
s_nop 0
buffer_load_dwordx4 v4, s[12:15], s82 offen lds
s_waitcnt vmcnt(8)
s_barrier
ds_read_b128 v[16:19], v6 offset:0
ds_read_b128 v[20:23], v6 offset:2048
ds_read_b64_tr_b16 v[40:41], v120 offset:0
ds_read_b64_tr_b16 v[42:43], v120 offset:512
ds_read_b64_tr_b16 v[44:45], v120 offset:8192
ds_read_b64_tr_b16 v[46:47], v120 offset:8704
ds_read_b64_tr_b16 v[48:49], v120 offset:16384
ds_read_b64_tr_b16 v[50:51], v120 offset:16896
ds_read_b128 v[24:27], v7 offset:0
ds_read_b128 v[28:31], v7 offset:2048
ds_read_b64_tr_b16 v[52:53], v120 offset:4096
ds_read_b64_tr_b16 v[54:55], v120 offset:4608
ds_read_b64_tr_b16 v[56:57], v120 offset:12288
ds_read_b64_tr_b16 v[58:59], v120 offset:12800
s_waitcnt lgkmcnt(12)
ds_read_b64_tr_b16 v[60:61], v120 offset:20480
ds_read_b64_tr_b16 v[62:63], v120 offset:20992
s_waitcnt vmcnt(4)
s_barrier
s_waitcnt lgkmcnt(8)
s_cmp_lt_u32 s26, 4
s_cbranch_scc0 P1_ND0
s_add_u32 m0, s40, 131072
s_add_u32 s41, s90, 0
buffer_load_dwordx4 v5, s[16:19], s41 offen lds
s_add_u32 m0, s40, 139264
s_add_u32 s41, s90, 896
buffer_load_dwordx4 v5, s[16:19], s41 offen lds
s_add_u32 m0, s40, 147456
s_add_u32 s41, s90, 1792
buffer_load_dwordx4 v5, s[16:19], s41 offen lds
s_add_u32 m0, s40, 24576
s_nop 0
buffer_load_dwordx4 v4, s[12:15], s83 offen lds
s_add_u32 m0, s40, 32768
s_nop 0
buffer_load_dwordx4 v4, s[12:15], s84 offen lds
P1_ND0:
v_mfma_f32_16x16x32_bf16 v[128:131], v[40:43], v[16:19], v[128:131]
v_mfma_f32_16x16x32_bf16 v[132:135], v[40:43], v[20:23], v[132:135]
ds_read_b128 v[32:35], v6 offset:8192
v_mfma_f32_16x16x32_bf16 v[136:139], v[40:43], v[12:15], v[136:139]
ds_read_b128 v[36:39], v6 offset:10240
v_mfma_f32_16x16x32_bf16 v[140:143], v[44:47], v[16:19], v[140:143]
ds_read_b64_tr_b16 v[64:65], v121 offset:0
v_mfma_f32_16x16x32_bf16 v[144:147], v[44:47], v[20:23], v[144:147]
ds_read_b64_tr_b16 v[66:67], v121 offset:512
v_mfma_f32_16x16x32_bf16 v[148:151], v[44:47], v[12:15], v[148:151]
ds_read_b64_tr_b16 v[68:69], v121 offset:8192
v_mfma_f32_16x16x32_bf16 v[152:155], v[16:19], v[48:51], v[152:155]
ds_read_b64_tr_b16 v[70:71], v121 offset:8704
v_mfma_f32_16x16x32_bf16 v[156:159], v[20:23], v[48:51], v[156:159]
ds_read_b64_tr_b16 v[72:73], v121 offset:16384
v_mfma_f32_16x16x32_bf16 v[160:163], v[12:15], v[48:51], v[160:163]
ds_read_b64_tr_b16 v[74:75], v121 offset:16896
s_waitcnt lgkmcnt(8)
s_cmp_lt_u32 s26, 4
s_cbranch_scc1 P1_ND1
s_add_u32 m0, s40, 131072
s_add_u32 s41, s90, 0
buffer_load_dwordx4 v5, s[16:19], s41 offen lds
s_add_u32 m0, s40, 139264
s_add_u32 s41, s90, 896
buffer_load_dwordx4 v5, s[16:19], s41 offen lds
s_add_u32 m0, s40, 147456
s_add_u32 s41, s90, 1792
buffer_load_dwordx4 v5, s[16:19], s41 offen lds
s_add_u32 m0, s40, 24576
s_nop 0
buffer_load_dwordx4 v4, s[12:15], s83 offen lds
s_add_u32 m0, s40, 32768
s_nop 0
buffer_load_dwordx4 v4, s[12:15], s84 offen lds
P1_ND1:
v_mfma_f32_16x16x32_bf16 v[128:131], v[52:55], v[24:27], v[128:131]
v_mfma_f32_16x16x32_bf16 v[132:135], v[52:55], v[28:31], v[132:135]
ds_read_b128 v[16:19], v7 offset:8192
v_mfma_f32_16x16x32_bf16 v[136:139], v[52:55], v[12:15], v[136:139]
ds_read_b128 v[20:23], v7 offset:10240
v_mfma_f32_16x16x32_bf16 v[140:143], v[56:59], v[24:27], v[140:143]
ds_read_b64_tr_b16 v[40:41], v121 offset:4096
v_mfma_f32_16x16x32_bf16 v[144:147], v[56:59], v[28:31], v[144:147]
ds_read_b64_tr_b16 v[42:43], v121 offset:4608
v_mfma_f32_16x16x32_bf16 v[148:151], v[56:59], v[12:15], v[148:151]
ds_read_b64_tr_b16 v[44:45], v121 offset:12288
v_mfma_f32_16x16x32_bf16 v[152:155], v[24:27], v[60:63], v[152:155]
ds_read_b64_tr_b16 v[46:47], v121 offset:12800
v_mfma_f32_16x16x32_bf16 v[156:159], v[28:31], v[60:63], v[156:159]
ds_read_b64_tr_b16 v[48:49], v121 offset:20480
v_mfma_f32_16x16x32_bf16 v[160:163], v[12:15], v[60:63], v[160:163]
ds_read_b64_tr_b16 v[50:51], v121 offset:20992
s_waitcnt vmcnt(5)
s_barrier
s_waitcnt lgkmcnt(8)
s_cmp_lt_u32 s26, 4
s_cbranch_scc0 P1_ND2
s_add_u32 m0, s40, 57344
s_add_u32 s41, s91, 0
buffer_load_dwordx4 v5, s[16:19], s41 offen lds
s_add_u32 m0, s40, 65536
s_add_u32 s41, s91, 896
buffer_load_dwordx4 v5, s[16:19], s41 offen lds
s_add_u32 m0, s40, 73728
s_add_u32 s41, s91, 1792
buffer_load_dwordx4 v5, s[16:19], s41 offen lds
s_add_u32 m0, s40, 40960
s_nop 0
buffer_load_dwordx4 v4, s[12:15], s85 offen lds
s_add_u32 m0, s40, 49152
s_nop 0
buffer_load_dwordx4 v4, s[12:15], s86 offen lds
P1_ND2:
v_mfma_f32_16x16x32_bf16 v[128:131], v[64:67], v[32:35], v[128:131]
v_mfma_f32_16x16x32_bf16 v[132:135], v[64:67], v[36:39], v[132:135]
ds_read_b128 v[24:27], v6 offset:16384
v_mfma_f32_16x16x32_bf16 v[136:139], v[64:67], v[12:15], v[136:139]
ds_read_b128 v[28:31], v6 offset:18432
v_mfma_f32_16x16x32_bf16 v[140:143], v[68:71], v[32:35], v[140:143]
ds_read_b64_tr_b16 v[52:53], v122 offset:0
v_mfma_f32_16x16x32_bf16 v[144:147], v[68:71], v[36:39], v[144:147]
ds_read_b64_tr_b16 v[54:55], v122 offset:512
v_mfma_f32_16x16x32_bf16 v[148:151], v[68:71], v[12:15], v[148:151]
ds_read_b64_tr_b16 v[56:57], v122 offset:8192
v_mfma_f32_16x16x32_bf16 v[152:155], v[32:35], v[72:75], v[152:155]
ds_read_b64_tr_b16 v[58:59], v122 offset:8704
v_mfma_f32_16x16x32_bf16 v[156:159], v[36:39], v[72:75], v[156:159]
ds_read_b64_tr_b16 v[60:61], v122 offset:16384
v_mfma_f32_16x16x32_bf16 v[160:163], v[12:15], v[72:75], v[160:163]
ds_read_b64_tr_b16 v[62:63], v122 offset:16896
s_waitcnt lgkmcnt(8)
s_cmp_lt_u32 s26, 4
s_cbranch_scc1 P1_ND3
s_add_u32 m0, s40, 57344
s_add_u32 s41, s91, 0
buffer_load_dwordx4 v5, s[16:19], s41 offen lds
s_add_u32 m0, s40, 65536
s_add_u32 s41, s91, 896
buffer_load_dwordx4 v5, s[16:19], s41 offen lds
s_add_u32 m0, s40, 73728
s_add_u32 s41, s91, 1792
buffer_load_dwordx4 v5, s[16:19], s41 offen lds
s_add_u32 m0, s40, 40960
s_nop 0
buffer_load_dwordx4 v4, s[12:15], s85 offen lds
s_add_u32 m0, s40, 49152
s_nop 0
buffer_load_dwordx4 v4, s[12:15], s86 offen lds
P1_ND3:
v_mfma_f32_16x16x32_bf16 v[128:131], v[40:43], v[16:19], v[128:131]
v_mfma_f32_16x16x32_bf16 v[132:135], v[40:43], v[20:23], v[132:135]
ds_read_b128 v[32:35], v7 offset:16384
v_mfma_f32_16x16x32_bf16 v[136:139], v[40:43], v[12:15], v[136:139]
ds_read_b128 v[36:39], v7 offset:18432
v_mfma_f32_16x16x32_bf16 v[140:143], v[44:47], v[16:19], v[140:143]
ds_read_b64_tr_b16 v[64:65], v122 offset:4096
v_mfma_f32_16x16x32_bf16 v[144:147], v[44:47], v[20:23], v[144:147]
ds_read_b64_tr_b16 v[66:67], v122 offset:4608
v_mfma_f32_16x16x32_bf16 v[148:151], v[44:47], v[12:15], v[148:151]
ds_read_b64_tr_b16 v[68:69], v122 offset:12288
v_mfma_f32_16x16x32_bf16 v[152:155], v[16:19], v[48:51], v[152:155]
ds_read_b64_tr_b16 v[70:71], v122 offset:12800
v_mfma_f32_16x16x32_bf16 v[156:159], v[20:23], v[48:51], v[156:159]
ds_read_b64_tr_b16 v[72:73], v122 offset:20480
v_mfma_f32_16x16x32_bf16 v[160:163], v[12:15], v[48:51], v[160:163]
ds_read_b64_tr_b16 v[74:75], v122 offset:20992
s_waitcnt vmcnt(6)
s_barrier
s_waitcnt lgkmcnt(8)
s_cmp_lt_u32 s26, 4
s_cbranch_scc0 P1_ND4
s_add_u32 m0, s40, 81920
s_add_u32 s41, s92, 0
buffer_load_dwordx4 v5, s[16:19], s41 offen lds
s_add_u32 m0, s40, 90112
s_add_u32 s41, s92, 896
buffer_load_dwordx4 v5, s[16:19], s41 offen lds
s_add_u32 m0, s40, 98304
s_add_u32 s41, s92, 1792
buffer_load_dwordx4 v5, s[16:19], s41 offen lds
P1_ND4:
v_mfma_f32_16x16x32_bf16 v[128:131], v[52:55], v[24:27], v[128:131]
v_mfma_f32_16x16x32_bf16 v[132:135], v[52:55], v[28:31], v[132:135]
ds_read_b128 v[16:19], v6 offset:24576
v_mfma_f32_16x16x32_bf16 v[136:139], v[52:55], v[12:15], v[136:139]
ds_read_b128 v[20:23], v6 offset:26624
v_mfma_f32_16x16x32_bf16 v[140:143], v[56:59], v[24:27], v[140:143]
ds_read_b64_tr_b16 v[40:41], v123 offset:0
v_mfma_f32_16x16x32_bf16 v[144:147], v[56:59], v[28:31], v[144:147]
ds_read_b64_tr_b16 v[42:43], v123 offset:512
v_mfma_f32_16x16x32_bf16 v[148:151], v[56:59], v[12:15], v[148:151]
ds_read_b64_tr_b16 v[44:45], v123 offset:8192
v_mfma_f32_16x16x32_bf16 v[152:155], v[24:27], v[60:63], v[152:155]
ds_read_b64_tr_b16 v[46:47], v123 offset:8704
v_mfma_f32_16x16x32_bf16 v[156:159], v[28:31], v[60:63], v[156:159]
ds_read_b64_tr_b16 v[48:49], v123 offset:16384
v_mfma_f32_16x16x32_bf16 v[160:163], v[12:15], v[60:63], v[160:163]
ds_read_b64_tr_b16 v[50:51], v123 offset:16896
s_waitcnt lgkmcnt(8)
s_cmp_lt_u32 s26, 4
s_cbranch_scc1 P1_ND5
s_add_u32 m0, s40, 81920
s_add_u32 s41, s92, 0
buffer_load_dwordx4 v5, s[16:19], s41 offen lds
s_add_u32 m0, s40, 90112
s_add_u32 s41, s92, 896
buffer_load_dwordx4 v5, s[16:19], s41 offen lds
s_add_u32 m0, s40, 98304
s_add_u32 s41, s92, 1792
buffer_load_dwordx4 v5, s[16:19], s41 offen lds
P1_ND5:
v_mfma_f32_16x16x32_bf16 v[128:131], v[64:67], v[32:35], v[128:131]
v_mfma_f32_16x16x32_bf16 v[132:135], v[64:67], v[36:39], v[132:135]
ds_read_b128 v[24:27], v7 offset:24576
v_mfma_f32_16x16x32_bf16 v[136:139], v[64:67], v[12:15], v[136:139]
ds_read_b128 v[28:31], v7 offset:26624
v_mfma_f32_16x16x32_bf16 v[140:143], v[68:71], v[32:35], v[140:143]
ds_read_b64_tr_b16 v[52:53], v123 offset:4096
v_mfma_f32_16x16x32_bf16 v[144:147], v[68:71], v[36:39], v[144:147]
ds_read_b64_tr_b16 v[54:55], v123 offset:4608
v_mfma_f32_16x16x32_bf16 v[148:151], v[68:71], v[12:15], v[148:151]
ds_read_b64_tr_b16 v[56:57], v123 offset:12288
v_mfma_f32_16x16x32_bf16 v[152:155], v[32:35], v[72:75], v[152:155]
ds_read_b64_tr_b16 v[58:59], v123 offset:12800
v_mfma_f32_16x16x32_bf16 v[156:159], v[36:39], v[72:75], v[156:159]
ds_read_b64_tr_b16 v[60:61], v123 offset:20480
v_mfma_f32_16x16x32_bf16 v[160:163], v[12:15], v[72:75], v[160:163]
ds_read_b64_tr_b16 v[62:63], v123 offset:20992
s_waitcnt vmcnt(5)
s_barrier
s_waitcnt lgkmcnt(8)
s_cmp_lt_u32 s26, 4
s_cbranch_scc0 P1_ND6
s_add_u32 m0, s40, 106496
s_add_u32 s41, s93, 0
buffer_load_dwordx4 v5, s[16:19], s41 offen lds
s_add_u32 m0, s40, 114688
s_add_u32 s41, s93, 896
buffer_load_dwordx4 v5, s[16:19], s41 offen lds
s_add_u32 m0, s40, 122880
s_add_u32 s41, s93, 1792
buffer_load_dwordx4 v5, s[16:19], s41 offen lds
P1_ND6:
v_mfma_f32_16x16x32_bf16 v[128:131], v[40:43], v[16:19], v[128:131]
v_mfma_f32_16x16x32_bf16 v[132:135], v[40:43], v[20:23], v[132:135]
ds_read_b128 v[32:35], v6 offset:32768
v_mfma_f32_16x16x32_bf16 v[136:139], v[40:43], v[12:15], v[136:139]
ds_read_b128 v[36:39], v6 offset:34816
v_mfma_f32_16x16x32_bf16 v[140:143], v[44:47], v[16:19], v[140:143]
ds_read_b64_tr_b16 v[64:65], v120 offset:0
v_mfma_f32_16x16x32_bf16 v[144:147], v[44:47], v[20:23], v[144:147]
ds_read_b64_tr_b16 v[66:67], v120 offset:512
v_mfma_f32_16x16x32_bf16 v[148:151], v[44:47], v[12:15], v[148:151]
ds_read_b64_tr_b16 v[68:69], v120 offset:8192
v_mfma_f32_16x16x32_bf16 v[152:155], v[16:19], v[48:51], v[152:155]
ds_read_b64_tr_b16 v[70:71], v120 offset:8704
v_mfma_f32_16x16x32_bf16 v[156:159], v[20:23], v[48:51], v[156:159]
ds_read_b64_tr_b16 v[72:73], v120 offset:16384
v_mfma_f32_16x16x32_bf16 v[160:163], v[12:15], v[48:51], v[160:163]
ds_read_b64_tr_b16 v[74:75], v120 offset:16896
s_waitcnt lgkmcnt(8)
s_cmp_lt_u32 s26, 4
s_cbranch_scc1 P1_ND7
s_add_u32 m0, s40, 106496
s_add_u32 s41, s93, 0
buffer_load_dwordx4 v5, s[16:19], s41 offen lds
s_add_u32 m0, s40, 114688
s_add_u32 s41, s93, 896
buffer_load_dwordx4 v5, s[16:19], s41 offen lds
s_add_u32 m0, s40, 122880
s_add_u32 s41, s93, 1792
buffer_load_dwordx4 v5, s[16:19], s41 offen lds
P1_ND7:
v_mfma_f32_16x16x32_bf16 v[128:131], v[52:55], v[24:27], v[128:131]
v_mfma_f32_16x16x32_bf16 v[132:135], v[52:55], v[28:31], v[132:135]
ds_read_b128 v[16:19], v7 offset:32768
v_mfma_f32_16x16x32_bf16 v[136:139], v[52:55], v[12:15], v[136:139]
ds_read_b128 v[20:23], v7 offset:34816
v_mfma_f32_16x16x32_bf16 v[140:143], v[56:59], v[24:27], v[140:143]
ds_read_b64_tr_b16 v[40:41], v120 offset:4096
v_mfma_f32_16x16x32_bf16 v[144:147], v[56:59], v[28:31], v[144:147]
ds_read_b64_tr_b16 v[42:43], v120 offset:4608
v_mfma_f32_16x16x32_bf16 v[148:151], v[56:59], v[12:15], v[148:151]
ds_read_b64_tr_b16 v[44:45], v120 offset:12288
v_mfma_f32_16x16x32_bf16 v[152:155], v[24:27], v[60:63], v[152:155]
ds_read_b64_tr_b16 v[46:47], v120 offset:12800
v_mfma_f32_16x16x32_bf16 v[156:159], v[28:31], v[60:63], v[156:159]
ds_read_b64_tr_b16 v[48:49], v120 offset:20480
v_mfma_f32_16x16x32_bf16 v[160:163], v[12:15], v[60:63], v[160:163]
ds_read_b64_tr_b16 v[50:51], v120 offset:20992
s_waitcnt vmcnt(3)
v_lshlrev_b32 v9, 4, v1
v_add_u32 v9, s40, v9
ds_read_b128 v[168:171], v9 offset:0
ds_read_b128 v[172:175], v9 offset:8192
ds_read_b128 v[176:179], v9 offset:16384
ds_read_b128 v[180:183], v9 offset:24576
ds_read_b128 v[184:187], v9 offset:32768
ds_read_b128 v[188:191], v9 offset:40960
ds_read_b128 v[192:195], v9 offset:49152
v_mov_b32 v10, 0
v_mov_b32 v11, 0
v_mov_b32 v98, 0
v_mov_b32 v99, 0
s_waitcnt lgkmcnt(6)
v_dot2c_f32_bf16 v10, v168, v12
v_dot2c_f32_bf16 v11, v168, v168
v_dot2c_f32_bf16 v98, v169, v12
v_dot2c_f32_bf16 v99, v169, v169
v_dot2c_f32_bf16 v10, v170, v12
v_dot2c_f32_bf16 v11, v170, v170
v_dot2c_f32_bf16 v98, v171, v12
v_dot2c_f32_bf16 v99, v171, v171
s_waitcnt lgkmcnt(5)
v_dot2c_f32_bf16 v10, v172, v12
v_dot2c_f32_bf16 v11, v172, v172
v_dot2c_f32_bf16 v98, v173, v12
v_dot2c_f32_bf16 v99, v173, v173
v_dot2c_f32_bf16 v10, v174, v12
v_dot2c_f32_bf16 v11, v174, v174
v_dot2c_f32_bf16 v98, v175, v12
v_dot2c_f32_bf16 v99, v175, v175
s_waitcnt lgkmcnt(4)
v_dot2c_f32_bf16 v10, v176, v12
v_dot2c_f32_bf16 v11, v176, v176
v_dot2c_f32_bf16 v98, v177, v12
v_dot2c_f32_bf16 v99, v177, v177
v_dot2c_f32_bf16 v10, v178, v12
v_dot2c_f32_bf16 v11, v178, v178
v_dot2c_f32_bf16 v98, v179, v12
v_dot2c_f32_bf16 v99, v179, v179
s_waitcnt lgkmcnt(3)
v_dot2c_f32_bf16 v10, v180, v12
v_dot2c_f32_bf16 v11, v180, v180
v_dot2c_f32_bf16 v98, v181, v12
v_dot2c_f32_bf16 v99, v181, v181
v_dot2c_f32_bf16 v10, v182, v12
v_dot2c_f32_bf16 v11, v182, v182
v_dot2c_f32_bf16 v98, v183, v12
v_dot2c_f32_bf16 v99, v183, v183
s_waitcnt lgkmcnt(2)
v_dot2c_f32_bf16 v10, v184, v12
v_dot2c_f32_bf16 v11, v184, v184
v_dot2c_f32_bf16 v98, v185, v12
v_dot2c_f32_bf16 v99, v185, v185
v_dot2c_f32_bf16 v10, v186, v12
v_dot2c_f32_bf16 v11, v186, v186
v_dot2c_f32_bf16 v98, v187, v12
v_dot2c_f32_bf16 v99, v187, v187
s_waitcnt lgkmcnt(1)
v_dot2c_f32_bf16 v10, v188, v12
v_dot2c_f32_bf16 v11, v188, v188
v_dot2c_f32_bf16 v98, v189, v12
v_dot2c_f32_bf16 v99, v189, v189
v_dot2c_f32_bf16 v10, v190, v12
v_dot2c_f32_bf16 v11, v190, v190
v_dot2c_f32_bf16 v98, v191, v12
v_dot2c_f32_bf16 v99, v191, v191
s_waitcnt lgkmcnt(0)
v_dot2c_f32_bf16 v10, v192, v12
v_dot2c_f32_bf16 v11, v192, v192
v_dot2c_f32_bf16 v98, v193, v12
v_dot2c_f32_bf16 v99, v193, v193
v_dot2c_f32_bf16 v10, v194, v12
v_dot2c_f32_bf16 v11, v194, v194
v_dot2c_f32_bf16 v98, v195, v12
v_dot2c_f32_bf16 v99, v195, v195
s_nop 2
v_add_f32 v10, v10, v98
v_add_f32 v11, v11, v99
s_nop 1
v_add_f32_dpp v10, v10, v10 quad_perm:[1,0,3,2] row_mask:0xf bank_mask:0xf
v_add_f32_dpp v11, v11, v11 quad_perm:[1,0,3,2] row_mask:0xf bank_mask:0xf
s_nop 1
v_add_f32_dpp v10, v10, v10 quad_perm:[2,3,0,1] row_mask:0xf bank_mask:0xf
v_add_f32_dpp v11, v11, v11 quad_perm:[2,3,0,1] row_mask:0xf bank_mask:0xf
s_nop 1
v_add_f32_dpp v10, v10, v10 row_half_mirror row_mask:0xf bank_mask:0xf
v_add_f32_dpp v11, v11, v11 row_half_mirror row_mask:0xf bank_mask:0xf
v_mul_f32 v10, 0x3b124925, v10
v_mul_f32 v11, 0x3b124925, v11
v_fma_f32 v11, -v10, v10, v11
v_max_f32 v11, 0, v11
v_add_f32 v11, 0x3727c5ac, v11
v_rsq_f32 v98, v11
s_nop 0
v_mul_f32 v99, v10, v98
v_sub_f32 v99, 0, v99
v_lshrrev_b32 v9, 3, v1
v_lshlrev_b32 v9, 3, v9
s_lshl_b32 s41, s26, 6
s_add_u32 s41, s41, 155648
v_add_u32 v9, s41, v9
ds_write_b64 v9, v[98:99]
s_waitcnt lgkmcnt(0)
s_barrier
s_waitcnt lgkmcnt(8)
s_lshr_b32 s52, s26, 1
s_and_b32 s53, s26, 1
s_lshl_b32 s54, s24, 2
s_add_u32 s54, s54, s52
v_mul_u32_u24 v196, 896, v2
v_lshlrev_b32 v197, 5, v3
v_add_u32 v196, v196, v197
s_mul_i32 s54, s54, 14336
s_lshl_b32 s55, s25, 7
s_lshl_b32 s56, s53, 4
s_add_u32 s55, s55, s56
s_add_u32 s54, s54, s55
buffer_load_dwordx4 v[240:243], v196, s[12:15], s54 offen
s_mov_b32 s48, s60
s_and_b32 s49, s61, 0xffff
s_mov_b32 s50, 3584
s_mov_b32 s51, 0x00020000
s_lshl_b32 s54, s25, 9
s_lshl_b32 s56, s26, 6
s_add_u32 s54, s54, s56
v_lshlrev_b32 v198, 3, v3
buffer_load_dwordx2 v[244:245], v198, s[48:51], s54 offen offset:0
buffer_load_dwordx2 v[246:247], v198, s[48:51], s54 offen offset:32
s_mov_b32 s48, s62
s_and_b32 s49, s63, 0xffff
s_mov_b32 s50, 896
s_mov_b32 s51, 0x00020000
buffer_load_dwordx4 v[248:251], v197, s[48:51], s55 offen
v_mfma_f32_16x16x32_bf16 v[128:131], v[64:67], v[32:35], v[128:131]
v_mfma_f32_16x16x32_bf16 v[132:135], v[64:67], v[36:39], v[132:135]
ds_read_b128 v[24:27], v6 offset:40960
v_mfma_f32_16x16x32_bf16 v[136:139], v[64:67], v[12:15], v[136:139]
ds_read_b128 v[28:31], v6 offset:43008
v_mfma_f32_16x16x32_bf16 v[140:143], v[68:71], v[32:35], v[140:143]
ds_read_b64_tr_b16 v[52:53], v121 offset:0
v_mfma_f32_16x16x32_bf16 v[144:147], v[68:71], v[36:39], v[144:147]
ds_read_b64_tr_b16 v[54:55], v121 offset:512
v_mfma_f32_16x16x32_bf16 v[148:151], v[68:71], v[12:15], v[148:151]
ds_read_b64_tr_b16 v[56:57], v121 offset:8192
v_mfma_f32_16x16x32_bf16 v[152:155], v[32:35], v[72:75], v[152:155]
ds_read_b64_tr_b16 v[58:59], v121 offset:8704
v_mfma_f32_16x16x32_bf16 v[156:159], v[36:39], v[72:75], v[156:159]
ds_read_b64_tr_b16 v[60:61], v121 offset:16384
v_mfma_f32_16x16x32_bf16 v[160:163], v[12:15], v[72:75], v[160:163]
ds_read_b64_tr_b16 v[62:63], v121 offset:16896
s_waitcnt lgkmcnt(8)
v_mfma_f32_16x16x32_bf16 v[128:131], v[40:43], v[16:19], v[128:131]
v_mfma_f32_16x16x32_bf16 v[132:135], v[40:43], v[20:23], v[132:135]
ds_read_b128 v[32:35], v7 offset:40960
v_mfma_f32_16x16x32_bf16 v[136:139], v[40:43], v[12:15], v[136:139]
ds_read_b128 v[36:39], v7 offset:43008
v_mfma_f32_16x16x32_bf16 v[140:143], v[44:47], v[16:19], v[140:143]
ds_read_b64_tr_b16 v[64:65], v121 offset:4096
v_mfma_f32_16x16x32_bf16 v[144:147], v[44:47], v[20:23], v[144:147]
ds_read_b64_tr_b16 v[66:67], v121 offset:4608
v_mfma_f32_16x16x32_bf16 v[148:151], v[44:47], v[12:15], v[148:151]
ds_read_b64_tr_b16 v[68:69], v121 offset:12288
v_mfma_f32_16x16x32_bf16 v[152:155], v[16:19], v[48:51], v[152:155]
ds_read_b64_tr_b16 v[70:71], v121 offset:12800
v_mfma_f32_16x16x32_bf16 v[156:159], v[20:23], v[48:51], v[156:159]
ds_read_b64_tr_b16 v[72:73], v121 offset:20480
v_mfma_f32_16x16x32_bf16 v[160:163], v[12:15], v[48:51], v[160:163]
ds_read_b64_tr_b16 v[74:75], v121 offset:20992
s_waitcnt vmcnt(4)
s_barrier
s_cmp_lg_u32 s26, 0
s_cbranch_scc1 NL1
buffer_load_dwordx2 v[124:125], v126, s[8:11], 0 offen sc1
NL1:
s_waitcnt lgkmcnt(8)
v_mfma_f32_16x16x32_bf16 v[128:131], v[52:55], v[24:27], v[128:131]
v_mfma_f32_16x16x32_bf16 v[132:135], v[52:55], v[28:31], v[132:135]
ds_read_b128 v[16:19], v6 offset:49152
v_mfma_f32_16x16x32_bf16 v[136:139], v[52:55], v[12:15], v[136:139]
ds_read_b128 v[20:23], v6 offset:51200
v_mfma_f32_16x16x32_bf16 v[140:143], v[56:59], v[24:27], v[140:143]
ds_read_b64_tr_b16 v[40:41], v122 offset:0
v_mfma_f32_16x16x32_bf16 v[144:147], v[56:59], v[28:31], v[144:147]
ds_read_b64_tr_b16 v[42:43], v122 offset:512
v_mfma_f32_16x16x32_bf16 v[148:151], v[56:59], v[12:15], v[148:151]
ds_read_b64_tr_b16 v[44:45], v122 offset:8192
v_mfma_f32_16x16x32_bf16 v[152:155], v[24:27], v[60:63], v[152:155]
ds_read_b64_tr_b16 v[46:47], v122 offset:8704
v_mfma_f32_16x16x32_bf16 v[156:159], v[28:31], v[60:63], v[156:159]
ds_read_b64_tr_b16 v[48:49], v122 offset:16384
v_mfma_f32_16x16x32_bf16 v[160:163], v[12:15], v[60:63], v[160:163]
ds_read_b64_tr_b16 v[50:51], v122 offset:16896
s_waitcnt lgkmcnt(8)
v_mfma_f32_16x16x32_bf16 v[128:131], v[64:67], v[32:35], v[128:131]
v_mfma_f32_16x16x32_bf16 v[132:135], v[64:67], v[36:39], v[132:135]
ds_read_b128 v[24:27], v7 offset:49152
v_mfma_f32_16x16x32_bf16 v[136:139], v[64:67], v[12:15], v[136:139]
ds_read_b128 v[28:31], v7 offset:51200
v_mfma_f32_16x16x32_bf16 v[140:143], v[68:71], v[32:35], v[140:143]
ds_read_b64_tr_b16 v[52:53], v122 offset:4096
v_mfma_f32_16x16x32_bf16 v[144:147], v[68:71], v[36:39], v[144:147]
ds_read_b64_tr_b16 v[54:55], v122 offset:4608
v_mfma_f32_16x16x32_bf16 v[148:151], v[68:71], v[12:15], v[148:151]
ds_read_b64_tr_b16 v[56:57], v122 offset:12288
v_mfma_f32_16x16x32_bf16 v[152:155], v[32:35], v[72:75], v[152:155]
ds_read_b64_tr_b16 v[58:59], v122 offset:12800
v_mfma_f32_16x16x32_bf16 v[156:159], v[36:39], v[72:75], v[156:159]
ds_read_b64_tr_b16 v[60:61], v122 offset:20480
v_mfma_f32_16x16x32_bf16 v[160:163], v[12:15], v[72:75], v[160:163]
ds_read_b64_tr_b16 v[62:63], v122 offset:20992
s_waitcnt lgkmcnt(8)
v_mfma_f32_16x16x32_bf16 v[128:131], v[40:43], v[16:19], v[128:131]
v_mfma_f32_16x16x32_bf16 v[132:135], v[40:43], v[20:23], v[132:135]
s_lshl_b32 s41, s27, 8
s_add_u32 s41, s41, 155648
v_lshlrev_b32 v10, 3, v2
v_add_u32 v10, s41, v10
v_lshlrev_b32 v11, 5, v3
v_add_u32 v11, s41, v11
v_mfma_f32_16x16x32_bf16 v[136:139], v[40:43], v[12:15], v[136:139]
ds_read_b64 v[100:101], v10 offset:0
v_mfma_f32_16x16x32_bf16 v[140:143], v[44:47], v[16:19], v[140:143]
ds_read_b128 v[104:107], v11 offset:0
v_mfma_f32_16x16x32_bf16 v[144:147], v[44:47], v[20:23], v[144:147]
v_mfma_f32_16x16x32_bf16 v[148:151], v[44:47], v[12:15], v[148:151]
ds_read_b128 v[108:111], v11 offset:16
v_mfma_f32_16x16x32_bf16 v[152:155], v[16:19], v[48:51], v[152:155]
ds_read_b64 v[102:103], v10 offset:128
v_mfma_f32_16x16x32_bf16 v[156:159], v[20:23], v[48:51], v[156:159]
ds_read_b128 v[112:115], v11 offset:128
v_mfma_f32_16x16x32_bf16 v[160:163], v[12:15], v[48:51], v[160:163]
ds_read_b128 v[116:119], v11 offset:144
s_waitcnt lgkmcnt(0)
v_mfma_f32_16x16x32_bf16 v[128:131], v[52:55], v[24:27], v[128:131]
v_mfma_f32_16x16x32_bf16 v[132:135], v[52:55], v[28:31], v[132:135]
v_mfma_f32_16x16x32_bf16 v[136:139], v[52:55], v[12:15], v[136:139]
v_mfma_f32_16x16x32_bf16 v[140:143], v[56:59], v[24:27], v[140:143]
v_mfma_f32_16x16x32_bf16 v[144:147], v[56:59], v[28:31], v[144:147]
v_mfma_f32_16x16x32_bf16 v[148:151], v[56:59], v[12:15], v[148:151]
v_mfma_f32_16x16x32_bf16 v[152:155], v[24:27], v[60:63], v[152:155]
v_mfma_f32_16x16x32_bf16 v[156:159], v[28:31], v[60:63], v[156:159]
v_mfma_f32_16x16x32_bf16 v[160:163], v[12:15], v[60:63], v[160:163]
v_mov_b32 v17, 0x3e8b97f6
v_mul_f32 v18, v17, v100
v_mul_f32 v19, v17, v101
v_mul_f32 v20, v17, v102
v_mul_f32 v21, v17, v103
s_nop 3
v_mul_f32 v24, v136, v19
v_mul_f32 v25, v137, v19
v_mul_f32 v26, v138, v19
v_mul_f32 v27, v139, v19
v_fma_f32 v24, v128, v18, v24
v_fma_f32 v25, v129, v18, v25
v_fma_f32 v26, v130, v18, v26
v_fma_f32 v27, v131, v18, v27
v_cvt_pk_bf16_f32 v40, v24, v25
v_cvt_pk_bf16_f32 v41, v26, v27
buffer_store_dwordx2 v[40:41], v96, s[20:23], s42 offen sc1
v_mul_f32 v28, v136, v21
v_mul_f32 v29, v137, v21
v_mul_f32 v30, v138, v21
v_mul_f32 v31, v139, v21
v_fma_f32 v28, v132, v20, v28
v_fma_f32 v29, v133, v20, v29
v_fma_f32 v30, v134, v20, v30
v_fma_f32 v31, v135, v20, v31
v_cvt_pk_bf16_f32 v42, v28, v29
v_cvt_pk_bf16_f32 v43, v30, v31
s_add_u32 s42, s42, 14336
buffer_store_dwordx2 v[42:43], v96, s[20:23], s42 offen sc1
v_mul_f32 v32, v148, v101
v_mul_f32 v33, v149, v101
v_mul_f32 v34, v150, v101
v_mul_f32 v35, v151, v101
v_fma_f32 v32, v140, v100, v32
v_fma_f32 v33, v141, v100, v33
v_fma_f32 v34, v142, v100, v34
v_fma_f32 v35, v143, v100, v35
v_cvt_pk_bf16_f32 v44, v32, v33
v_cvt_pk_bf16_f32 v45, v34, v35
buffer_store_dwordx2 v[44:45], v96, s[20:23], s43 offen sc1
v_mul_f32 v36, v148, v103
v_mul_f32 v37, v149, v103
v_mul_f32 v38, v150, v103
v_mul_f32 v39, v151, v103
v_fma_f32 v36, v144, v102, v36
v_fma_f32 v37, v145, v102, v37
v_fma_f32 v38, v146, v102, v38
v_fma_f32 v39, v147, v102, v39
v_cvt_pk_bf16_f32 v46, v36, v37
v_cvt_pk_bf16_f32 v47, v38, v39
s_add_u32 s43, s43, 14336
buffer_store_dwordx2 v[46:47], v96, s[20:23], s43 offen sc1
v_mul_f32 v24, v160, v105
v_mul_f32 v25, v161, v107
v_mul_f32 v26, v162, v109
v_mul_f32 v27, v163, v111
v_fma_f32 v24, v152, v104, v24
v_fma_f32 v25, v153, v106, v25
v_fma_f32 v26, v154, v108, v26
v_fma_f32 v27, v155, v110, v27
v_cvt_pk_bf16_f32 v48, v24, v25
v_cvt_pk_bf16_f32 v49, v26, v27
v_mul_f32 v28, v160, v113
v_mul_f32 v29, v161, v115
v_mul_f32 v30, v162, v117
v_mul_f32 v31, v163, v119
v_fma_f32 v28, v156, v112, v28
v_fma_f32 v29, v157, v114, v29
v_fma_f32 v30, v158, v116, v30
v_fma_f32 v31, v159, v118, v31
v_cvt_pk_bf16_f32 v50, v28, v29
v_cvt_pk_bf16_f32 v51, v30, v31
buffer_store_dwordx4 v[48:51], v97, s[20:23], s44 offen sc1
v_lshlrev_b32 v4, 4, v1
s_waitcnt vmcnt(0)
s_cmp_lg_u32 s26, 0
s_cbranch_scc1 WP1_A
s_mov_b32 s51, 0
s_branch NGP1_CHK
NGP1_LOOP:
buffer_load_dwordx2 v[124:125], v126, s[8:11], 0 offen sc1
s_add_u32 s51, s51, 1
s_waitcnt vmcnt(0)
NGP1_CHK:
v_readfirstlane_b32 s58, v124
v_readfirstlane_b32 s59, v125
s_cmp_gt_u32 s51, 16384
s_cbranch_scc1 NGP1_DONE
s_cmp_eq_u32 s59, 0
s_cbranch_scc1 NGP1_LOOP
NGP1_DONE:
WP1_A:
s_barrier
s_cmp_lg_u32 s26, 0
s_cbranch_scc1 WP1_B
v_mov_b32 v6, s58
v_mov_b32 v7, s59
v_add_u32 v5, s24, v1
v_cmp_gt_u32 vcc, 32, v5
v_lshlrev_b32 v5, 10, v5
v_sub_u32 v8, 4, v1
v_lshlrev_b32 v8, 6, v8
v_add_u32 v5, v5, v8
s_lshl_b32 s50, s25, 3
s_add_u32 s50, s50, 65536
s_and_b64 s[52:53], vcc, 0x1f
s_mov_b64 exec, s[52:53]
buffer_store_dwordx2 v[6:7], v5, s[20:23], s50 offen sc1
s_mov_b64 exec, -1
WP1_B:
s_cmp_lg_u32 s26, 0
s_cbranch_scc1 WP1_C
s_lshl_b32 s50, s24, 10
s_add_u32 s50, s50, 65536
s_sub_i32 s51, 4, s24
s_max_i32 s51, s51, 0
s_lshl_b32 s51, s51, 2
s_mov_b32 s52, -1
s_lshl_b32 s52, s52, s51
s_mov_b32 s53, 0xf
s_mov_b32 s51, 0
buffer_load_dwordx4 v[112:115], v4, s[20:23], s50 offen sc1
POLL_S1:
s_waitcnt vmcnt(0)
v_cmp_eq_u32 s[54:55], s58, v112
v_cmp_eq_u32 s[56:57], s59, v113
v_cmp_eq_u32 s[44:45], s58, v114
v_cmp_eq_u32 s[46:47], s59, v115
s_add_u32 s51, s51, 1
s_and_b64 s[54:55], s[54:55], s[56:57]
s_and_b64 s[44:45], s[44:45], s[46:47]
s_and_b64 s[54:55], s[54:55], s[44:45]
s_and_b64 s[54:55], s[54:55], s[52:53]
s_cmp_eq_u64 s[54:55], s[52:53]
s_cbranch_scc1 POLLX_S1
buffer_load_dwordx4 v[112:115], v4, s[20:23], s50 offen sc1
s_cmp_lt_u32 s51, 16384
s_cbranch_scc1 POLL_S1
POLLX_S1:
WP1_C:
s_barrier
s_branch K_P2
K_RELAYOUT:
s_mov_b32 s12, s4
s_and_b32 s13, s5, 0xffff
s_mov_b32 s14, 1835008
s_mov_b32 s15, 0x00020000
s_mov_b32 s28, 0
RL_ENTRY:
v_mov_b32 v126, 0
s_lshl_b32 s27, s24, 3
s_add_u32 s27, s27, s26
v_lshrrev_b32 v9, 3, v1
v_and_b32 v10, 7, v1
v_lshlrev_b32 v10, 4, v10
v_lshrrev_b32 v12, 2, v2
v_and_b32 v13, 3, v2
s_lshl_b32 s40, s26, 13
s_lshl_b32 s29, s28, 8
s_add_u32 s29, s29, s27
s_mov_b32 s41, 3
s_cmp_ge_u32 s29, 441
s_cbranch_scc1 RL_DONE
s_mov_b32 s41, 0
s_mov_b32 s44, s30
s_mov_b32 s45, s31
s_mov_b32 s46, 401408
s_movk_i32 s48, 896
s_movk_i32 s42, 9363
s_movk_i32 s43, 7
s_movk_i32 s49, 14
s_mov_b32 s38, 18874368
s_cmp_lt_u32 s29, 49
s_cbranch_scc1 RL_GO
s_sub_u32 s29, s29, 49
s_mov_b32 s41, 1
s_mov_b32 s44, s32
s_mov_b32 s45, s33
s_mov_b32 s46, 1605632
s_movk_i32 s48, 3584
s_movk_i32 s42, 2341
s_movk_i32 s43, 28
s_movk_i32 s49, 28
s_mov_b32 s38, 19398656
s_cmp_lt_u32 s29, 196
s_cbranch_scc1 RL_GO
s_sub_u32 s29, s29, 196
s_mov_b32 s41, 2
s_mov_b32 s44, s34
s_mov_b32 s45, s35
s_mov_b32 s46, 1605632
s_movk_i32 s48, 896
s_movk_i32 s42, 9363
s_movk_i32 s43, 7
s_movk_i32 s49, 56
s_mov_b32 s38, 21102592
RL_GO:
s_mul_i32 s36, s29, s42
s_lshr_b32 s36, s36, 16
s_mul_i32 s37, s36, s43
s_sub_u32 s37, s29, s37
s_and_b32 s45, s45, 0xffff
s_mov_b32 s47, 0x00020000
v_mul_lo_u32 v11, v9, s48
v_add_u32 v11, v11, v10
s_mul_i32 s39, s36, s48
s_lshl_b32 s39, s39, 6
s_lshl_b32 s29, s37, 7
s_add_u32 s39, s39, s29
s_lshl_b32 s48, s48, 3
s_add_u32 m0, s40, 0
s_nop 0
buffer_load_dwordx4 v11, s[44:47], s39 offen lds
s_add_u32 m0, s40, 1024
s_add_u32 s39, s39, s48
buffer_load_dwordx4 v11, s[44:47], s39 offen lds
s_add_u32 m0, s40, 2048
s_add_u32 s39, s39, s48
buffer_load_dwordx4 v11, s[44:47], s39 offen lds
s_add_u32 m0, s40, 3072
s_add_u32 s39, s39, s48
buffer_load_dwordx4 v11, s[44:47], s39 offen lds
s_add_u32 m0, s40, 4096
s_add_u32 s39, s39, s48
buffer_load_dwordx4 v11, s[44:47], s39 offen lds
s_add_u32 m0, s40, 5120
s_add_u32 s39, s39, s48
buffer_load_dwordx4 v11, s[44:47], s39 offen lds
s_add_u32 m0, s40, 6144
s_add_u32 s39, s39, s48
buffer_load_dwordx4 v11, s[44:47], s39 offen lds
s_add_u32 m0, s40, 7168
s_add_u32 s39, s39, s48
buffer_load_dwordx4 v11, s[44:47], s39 offen lds
s_mul_i32 s37, s37, s49
s_lshl_b32 s36, s36, 1
s_add_u32 s37, s37, s36
s_cmp_eq_u32 s41, 1
s_cselect_b32 s36, 11, 12
s_lshl_b32 s37, s37, s36
s_add_u32 s37, s37, s38
s_cmp_eq_u32 s41, 1
s_movk_i32 s42, 4096
s_movk_i32 s44, 2048
s_movk_i32 s45, 4096
s_cselect_b32 s42, 1024, s42
s_cselect_b32 s43, 32, 8
s_cselect_b32 s44, 28672, s44
s_cselect_b32 s45, 2048, s45
s_cselect_b32 s46, 4, 3
s_cselect_b32 s47, 3, 5
s_movk_i32 s48, 512
s_cmp_eq_u32 s41, 2
s_cselect_b32 s46, 2, s46
s_cselect_b32 s48, 2048, s48
v_lshlrev_b32 v11, s46, v3
v_add_u32 v11, v11, v12
v_lshlrev_b32 v11, 7, v11
v_lshlrev_b32 v14, s47, v13
v_add_u32 v11, v11, v14
v_add_u32 v11, s40, v11
s_waitcnt vmcnt(0)
s_cmp_lg_u32 s26, 0
s_cbranch_scc1 NL2
buffer_load_dwordx2 v[124:125], v126, s[8:11], 0 offen sc1
NL2:
v_mov_b32 v14, v11
v_add_u32 v15, s48, v14
ds_read_b64_tr_b16 v[16:17], v14
ds_read_b64_tr_b16 v[18:19], v15
v_add_u32 v14, s43, v14
v_add_u32 v15, s48, v14
ds_read_b64_tr_b16 v[20:21], v14
ds_read_b64_tr_b16 v[22:23], v15
v_add_u32 v14, s43, v14
v_add_u32 v15, s48, v14
ds_read_b64_tr_b16 v[24:25], v14
ds_read_b64_tr_b16 v[26:27], v15
v_add_u32 v14, s43, v14
v_add_u32 v15, s48, v14
ds_read_b64_tr_b16 v[28:29], v14
ds_read_b64_tr_b16 v[30:31], v15
v_add_u32 v11, s42, v11
v_mov_b32 v14, v11
v_add_u32 v15, s48, v14
ds_read_b64_tr_b16 v[32:33], v14
ds_read_b64_tr_b16 v[34:35], v15
v_add_u32 v14, s43, v14
v_add_u32 v15, s48, v14
ds_read_b64_tr_b16 v[36:37], v14
ds_read_b64_tr_b16 v[38:39], v15
v_add_u32 v14, s43, v14
v_add_u32 v15, s48, v14
ds_read_b64_tr_b16 v[40:41], v14
ds_read_b64_tr_b16 v[42:43], v15
v_add_u32 v14, s43, v14
v_add_u32 v15, s48, v14
ds_read_b64_tr_b16 v[44:45], v14
ds_read_b64_tr_b16 v[46:47], v15
s_waitcnt lgkmcnt(0)
s_add_u32 s29, s37, s44
buffer_store_dwordx4 v[16:19], v4, s[20:23], s37 offen offset:0 sc1
buffer_store_dwordx4 v[20:23], v4, s[20:23], s37 offen offset:1024 sc1
buffer_store_dwordx4 v[24:27], v4, s[20:23], s29 offen offset:0 sc1
buffer_store_dwordx4 v[28:31], v4, s[20:23], s29 offen offset:1024 sc1
s_add_u32 s37, s37, s45
s_add_u32 s29, s37, s44
buffer_store_dwordx4 v[32:35], v4, s[20:23], s37 offen offset:0 sc1
buffer_store_dwordx4 v[36:39], v4, s[20:23], s37 offen offset:1024 sc1
buffer_store_dwordx4 v[40:43], v4, s[20:23], s29 offen offset:0 sc1
buffer_store_dwordx4 v[44:47], v4, s[20:23], s29 offen offset:1024 sc1
RL_DONE:
s_waitcnt vmcnt(0)
s_barrier
s_cmp_lg_u32 s26, 0
s_cbranch_scc1 RL_NF
s_cmp_eq_u32 s28, 0
s_cbranch_scc0 RL_F2
s_mov_b32 s51, 0
s_branch NGRL_CHK
NGRL_LOOP:
buffer_load_dwordx2 v[124:125], v126, s[8:11], 0 offen sc1
s_add_u32 s51, s51, 1
s_waitcnt vmcnt(0)
NGRL_CHK:
v_readfirstlane_b32 s58, v124
v_readfirstlane_b32 s59, v125
s_cmp_gt_u32 s51, 16384
s_cbranch_scc1 NGRL_DONE
s_cmp_eq_u32 s59, 0
s_cbranch_scc1 NGRL_LOOP
NGRL_DONE:
v_mov_b32 v6, s58
v_mov_b32 v7, s59
s_mov_b64 exec, 0xffffffff
v_lshlrev_b32 v5, 10, v1
s_lshl_b32 s50, s24, 3
s_add_u32 s50, s50, 65856
buffer_store_dwordx2 v[6:7], v5, s[20:23], s50 offen sc1
s_mov_b64 exec, -1
v_mov_b32 v6, s58
v_mov_b32 v7, s59
v_add_u32 v5, s24, v1
v_cmp_gt_u32 vcc, 32, v5
v_lshlrev_b32 v5, 10, v5
v_sub_u32 v8, 4, v1
v_lshlrev_b32 v8, 6, v8
v_add_u32 v5, v5, v8
s_lshl_b32 s50, s25, 3
s_add_u32 s50, s50, 65536
s_and_b64 s[52:53], vcc, 0x1f
s_mov_b64 exec, s[52:53]
buffer_store_dwordx2 v[6:7], v5, s[20:23], s50 offen sc1
s_mov_b64 exec, -1
s_branch RL_NF
RL_F2:
v_mov_b32 v6, s58
v_mov_b32 v7, s59
s_mov_b64 exec, 0xffffffff
v_lshlrev_b32 v5, 10, v1
s_lshl_b32 s50, s24, 3
s_add_u32 s50, s50, 66112
buffer_store_dwordx2 v[6:7], v5, s[20:23], s50 offen sc1
s_mov_b64 exec, -1
RL_NF:
s_cmp_eq_u32 s28, 0
s_cbranch_scc0 K_FIN
s_cmp_lg_u32 s26, 0
s_cbranch_scc1 RLS1
s_lshl_b32 s50, s24, 10
s_add_u32 s50, s50, 65536
s_sub_i32 s51, 4, s24
s_max_i32 s51, s51, 0
s_lshl_b32 s51, s51, 2
s_mov_b32 s52, -1
s_lshl_b32 s52, s52, s51
s_mov_b32 s53, 0xf
s_mov_b32 s51, 0
buffer_load_dwordx4 v[112:115], v4, s[20:23], s50 offen sc1
POLL_S1b:
s_waitcnt vmcnt(0)
v_cmp_eq_u32 s[54:55], s58, v112
v_cmp_eq_u32 s[56:57], s59, v113
v_cmp_eq_u32 s[44:45], s58, v114
v_cmp_eq_u32 s[46:47], s59, v115
s_add_u32 s51, s51, 1
s_and_b64 s[54:55], s[54:55], s[56:57]
s_and_b64 s[44:45], s[44:45], s[46:47]
s_and_b64 s[54:55], s[54:55], s[44:45]
s_and_b64 s[54:55], s[54:55], s[52:53]
s_cmp_eq_u64 s[54:55], s[52:53]
s_cbranch_scc1 POLLX_S1b
buffer_load_dwordx4 v[112:115], v4, s[20:23], s50 offen sc1
s_cmp_lt_u32 s51, 16384
s_cbranch_scc1 POLL_S1b
POLLX_S1b:
RLS1:
s_barrier
K_P2:
s_lshr_b32 s27, s26, 2
s_and_b32 s28, s26, 3
s_lshl_b32 s29, s25, 1
s_add_u32 s29, s29, s27
s_lshl_b32 s30, s24, 2
s_add_u32 s30, s30, s28
s_mul_i32 s31, s29, 896
s_mul_i32 s32, s30, 14336
s_add_u32 s32, s32, s31
s_add_u32 s32, s32, 1048576
v_lshlrev_b32 v5, 8, v3
v_lshlrev_b32 v6, 3, v2
v_add_u32 v100, v5, v6
s_mul_i32 s33, s27, 40960
s_mul_i32 s34, s28, 5
s_lshl_b32 s35, s24, 2
s_sub_i32 s35, s35, 16
s_add_i32 s35, s35, s34
s_lshl_b32 s36, s34, 10
s_add_u32 s36, s36, s33
s_add_u32 s39, s31, 3145728
s_add_i32 s37, s35, 0
s_max_i32 s37, s37, 0
s_mul_i32 s37, s37, 14336
s_add_u32 s37, s37, s39
s_add_u32 m0, s36, 0
s_nop 0
buffer_load_dwordx4 v4, s[20:23], s37 offen sc1 lds
s_add_i32 s37, s35, 1
s_max_i32 s37, s37, 0
s_mul_i32 s37, s37, 14336
s_add_u32 s37, s37, s39
s_add_u32 m0, s36, 1024
s_nop 0
buffer_load_dwordx4 v4, s[20:23], s37 offen sc1 lds
s_add_i32 s37, s35, 2
s_max_i32 s37, s37, 0
s_mul_i32 s37, s37, 14336
s_add_u32 s37, s37, s39
s_add_u32 m0, s36, 2048
s_nop 0
buffer_load_dwordx4 v4, s[20:23], s37 offen sc1 lds
s_add_i32 s37, s35, 3
s_max_i32 s37, s37, 0
s_mul_i32 s37, s37, 14336
s_add_u32 s37, s37, s39
s_add_u32 m0, s36, 3072
s_nop 0
buffer_load_dwordx4 v4, s[20:23], s37 offen sc1 lds
s_add_i32 s37, s35, 4
s_max_i32 s37, s37, 0
s_mul_i32 s37, s37, 14336
s_add_u32 s37, s37, s39
s_add_u32 m0, s36, 4096
s_nop 0
buffer_load_dwordx4 v4, s[20:23], s37 offen sc1 lds
buffer_load_dwordx2 v[8:9], v100, s[20:23], s32 offen sc1
buffer_load_dwordx2 v[10:11], v100, s[20:23], s32 offen offset:128 sc1
v_mul_u32_u24 v101, 7168, v3
v_lshlrev_b32 v5, 4, v2
v_add_u32 v101, v101, v5
s_mul_i32 s39, s29, 448
s_add_u32 s39, s39, 5242880
s_add_i32 s37, s35, 0
s_and_b32 s38, s37, 1
s_ashr_i32 s37, s37, 1
s_max_i32 s37, s37, 0
s_mul_i32 s37, s37, 28672
s_lshl_b32 s38, s38, 8
s_add_u32 s37, s37, s38
s_add_u32 s37, s37, s39
s_add_u32 m0, s36, 20480
s_nop 0
buffer_load_dwordx4 v101, s[20:23], s37 offen sc1 lds
s_add_i32 s37, s35, 1
s_and_b32 s38, s37, 1
s_ashr_i32 s37, s37, 1
s_max_i32 s37, s37, 0
s_mul_i32 s37, s37, 28672
s_lshl_b32 s38, s38, 8
s_add_u32 s37, s37, s38
s_add_u32 s37, s37, s39
s_add_u32 m0, s36, 21504
s_nop 0
buffer_load_dwordx4 v101, s[20:23], s37 offen sc1 lds
s_add_i32 s37, s35, 2
s_and_b32 s38, s37, 1
s_ashr_i32 s37, s37, 1
s_max_i32 s37, s37, 0
s_mul_i32 s37, s37, 28672
s_lshl_b32 s38, s38, 8
s_add_u32 s37, s37, s38
s_add_u32 s37, s37, s39
s_add_u32 m0, s36, 22528
s_nop 0
buffer_load_dwordx4 v101, s[20:23], s37 offen sc1 lds
s_add_i32 s37, s35, 3
s_and_b32 s38, s37, 1
s_ashr_i32 s37, s37, 1
s_max_i32 s37, s37, 0
s_mul_i32 s37, s37, 28672
s_lshl_b32 s38, s38, 8
s_add_u32 s37, s37, s38
s_add_u32 s37, s37, s39
s_add_u32 m0, s36, 23552
s_nop 0
buffer_load_dwordx4 v101, s[20:23], s37 offen sc1 lds
s_add_i32 s37, s35, 4
s_and_b32 s38, s37, 1
s_ashr_i32 s37, s37, 1
s_max_i32 s37, s37, 0
s_mul_i32 s37, s37, 28672
s_lshl_b32 s38, s38, 8
s_add_u32 s37, s37, s38
s_add_u32 s37, s37, s39
s_add_u32 m0, s36, 24576
s_nop 0
buffer_load_dwordx4 v101, s[20:23], s37 offen sc1 lds
v_mov_b32 v28, 0xf149f2ca
v_mov_b32 v29, 0
v_lshlrev_b32 v5, 2, v3
s_and_b32 s38, s28, 1
s_cmp_eq_u32 s38, 0
s_cselect_b64 s[40:41], -1, 0
v_add_u32 v6, 0, v5
v_cmp_gt_u32 vcc, v6, v2
s_nop 1
v_cndmask_b32 v30, v28, v29, vcc
v_cndmask_b32 v31, v29, v28, vcc
v_cndmask_b32 v12, v28, v30, s[40:41]
v_cndmask_b32 v16, v30, v29, s[40:41]
v_cndmask_b32 v20, v29, v31, s[40:41]
v_cndmask_b32 v24, v31, v28, s[40:41]
v_add_u32 v6, 1, v5
v_cmp_gt_u32 vcc, v6, v2
s_nop 1
v_cndmask_b32 v30, v28, v29, vcc
v_cndmask_b32 v31, v29, v28, vcc
v_cndmask_b32 v13, v28, v30, s[40:41]
v_cndmask_b32 v17, v30, v29, s[40:41]
v_cndmask_b32 v21, v29, v31, s[40:41]
v_cndmask_b32 v25, v31, v28, s[40:41]
v_add_u32 v6, 2, v5
v_cmp_gt_u32 vcc, v6, v2
s_nop 1
v_cndmask_b32 v30, v28, v29, vcc
v_cndmask_b32 v31, v29, v28, vcc
v_cndmask_b32 v14, v28, v30, s[40:41]
v_cndmask_b32 v18, v30, v29, s[40:41]
v_cndmask_b32 v22, v29, v31, s[40:41]
v_cndmask_b32 v26, v31, v28, s[40:41]
v_add_u32 v6, 3, v5
v_cmp_gt_u32 vcc, v6, v2
s_nop 1
v_cndmask_b32 v30, v28, v29, vcc
v_cndmask_b32 v31, v29, v28, vcc
v_cndmask_b32 v15, v28, v30, s[40:41]
v_cndmask_b32 v19, v30, v29, s[40:41]
v_cndmask_b32 v23, v29, v31, s[40:41]
v_cndmask_b32 v27, v31, v28, s[40:41]
s_and_b32 s38, s28, 2
s_lshl_b32 s39, s38, 10
s_add_u32 s39, s39, s33
v_add_u32 v5, s39, v100
v_add_u32 v7, 128, v5
v_cmp_eq_u32 vcc, 3, v3
s_nop 1
v_cndmask_b32 v7, v7, v5, vcc
s_add_u32 s39, s39, 20480
v_add_u32 v6, s39, v4
v_lshlrev_b32 v30, 3, v1
s_mul_i32 s42, s30, 14336
s_add_u32 s42, s42, s31
s_add_u32 s42, s42, 7340032
s_mov_b32 s49, s42
s_waitcnt vmcnt(5)
s_barrier
s_min_u32 s46, s25, 6
s_mul_i32 s43, s46, 57344
s_mul_i32 s44, s26, 7168
s_add_u32 s43, s43, s44
s_add_u32 s43, s43, 18874368
s_min_u32 s46, s25, 6
s_lshl_b32 s47, s46, 3
s_add_u32 s47, s47, s26
s_mul_i32 s47, s47, 28672
s_add_u32 s47, s47, 19398656
s_mov_b32 exec_lo, 0
s_mov_b32 exec_hi, 0xffff0000
v_mov_b32 v10, 0
v_mov_b32 v11, 0
s_mov_b64 exec, -1
ds_read_b64 v[104:105], v5 offset:0
ds_read_b64 v[106:107], v7 offset:0
ds_read_b64 v[108:109], v5 offset:1024
ds_read_b64 v[110:111], v7 offset:1024
ds_read_b64 v[112:113], v5 offset:2048
ds_read_b64 v[114:115], v7 offset:2048
ds_read_b64 v[116:117], v5 offset:3072
ds_read_b64 v[118:119], v7 offset:3072
ds_read_b64 v[120:121], v5 offset:4096
ds_read_b64 v[122:123], v7 offset:4096
ds_read_b64 v[124:125], v5 offset:5120
ds_read_b64 v[126:127], v7 offset:5120
ds_read_b64 v[128:129], v5 offset:6144
ds_read_b64 v[130:131], v7 offset:6144
s_waitcnt lgkmcnt(12)
v_mfma_f32_16x16x32_bf16 v[32:35], v[104:107], v[8:11], v[12:15]
ds_read_b64 v[132:133], v5 offset:7168
ds_read_b64 v[134:135], v7 offset:7168
s_waitcnt lgkmcnt(12)
v_mfma_f32_16x16x32_bf16 v[36:39], v[108:111], v[8:11], v[16:19]
s_add_u32 m0, s44, 81920
s_add_u32 s45, s43, 0
buffer_load_dwordx4 v4, s[20:23], s45 offen sc1 lds
ds_read_b64 v[104:105], v5 offset:8192
ds_read_b64 v[106:107], v7 offset:8192
s_waitcnt lgkmcnt(12)
v_mfma_f32_16x16x32_bf16 v[40:43], v[112:115], v[8:11], 0
ds_read_b64 v[108:109], v5 offset:9216
ds_read_b64 v[110:111], v7 offset:9216
s_waitcnt lgkmcnt(12)
v_mfma_f32_16x16x32_bf16 v[44:47], v[116:119], v[8:11], 0
ds_read_b64 v[112:113], v5 offset:10240
ds_read_b64 v[114:115], v7 offset:10240
s_waitcnt lgkmcnt(12)
v_mfma_f32_16x16x32_bf16 v[48:51], v[120:123], v[8:11], 0
s_add_u32 m0, s44, 82944
s_add_u32 s45, s43, 1024
buffer_load_dwordx4 v4, s[20:23], s45 offen sc1 lds
ds_read_b64 v[116:117], v5 offset:11264
ds_read_b64 v[118:119], v7 offset:11264
s_waitcnt lgkmcnt(12)
v_mfma_f32_16x16x32_bf16 v[52:55], v[124:127], v[8:11], 0
ds_read_b64 v[120:121], v5 offset:12288
ds_read_b64 v[122:123], v7 offset:12288
s_waitcnt lgkmcnt(12)
v_mfma_f32_16x16x32_bf16 v[56:59], v[128:131], v[8:11], 0
ds_read_b64 v[124:125], v5 offset:13312
ds_read_b64 v[126:127], v7 offset:13312
s_waitcnt lgkmcnt(12)
v_mfma_f32_16x16x32_bf16 v[60:63], v[132:135], v[8:11], 0
s_add_u32 m0, s44, 83968
s_add_u32 s45, s43, 2048
buffer_load_dwordx4 v4, s[20:23], s45 offen sc1 lds
ds_read_b64 v[128:129], v5 offset:14336
ds_read_b64 v[130:131], v7 offset:14336
s_waitcnt lgkmcnt(12)
v_mfma_f32_16x16x32_bf16 v[64:67], v[104:107], v[8:11], 0
ds_read_b64 v[132:133], v5 offset:15360
ds_read_b64 v[134:135], v7 offset:15360
s_waitcnt lgkmcnt(12)
v_mfma_f32_16x16x32_bf16 v[68:71], v[108:111], v[8:11], 0
ds_read_b64 v[104:105], v5 offset:16384
ds_read_b64 v[106:107], v7 offset:16384
s_waitcnt lgkmcnt(12)
v_mfma_f32_16x16x32_bf16 v[72:75], v[112:115], v[8:11], 0
s_add_u32 m0, s44, 84992
s_add_u32 s45, s43, 3072
buffer_load_dwordx4 v4, s[20:23], s45 offen sc1 lds
ds_read_b64 v[108:109], v5 offset:17408
ds_read_b64 v[110:111], v7 offset:17408
s_waitcnt lgkmcnt(12)
v_mfma_f32_16x16x32_bf16 v[76:79], v[116:119], v[8:11], 0
s_waitcnt lgkmcnt(10)
v_mfma_f32_16x16x32_bf16 v[80:83], v[120:123], v[8:11], 0
s_waitcnt lgkmcnt(8)
v_mfma_f32_16x16x32_bf16 v[84:87], v[124:127], v[8:11], 0
s_add_u32 m0, s44, 86016
s_add_u32 s45, s43, 4096
buffer_load_dwordx4 v4, s[20:23], s45 offen sc1 lds
s_waitcnt lgkmcnt(6)
v_mfma_f32_16x16x32_bf16 v[88:91], v[128:131], v[8:11], 0
s_waitcnt lgkmcnt(4)
v_mfma_f32_16x16x32_bf16 v[92:95], v[132:135], v[8:11], 0
s_waitcnt lgkmcnt(2)
v_mfma_f32_16x16x32_bf16 v[96:99], v[104:107], v[8:11], v[20:23]
s_add_u32 m0, s44, 87040
s_add_u32 s45, s43, 5120
buffer_load_dwordx4 v4, s[20:23], s45 offen sc1 lds
s_waitcnt lgkmcnt(0)
v_mfma_f32_16x16x32_bf16 v[100:103], v[108:111], v[8:11], v[24:27]
s_waitcnt vmcnt(6)
s_barrier
ds_read_b128 v[104:107], v6 offset:0
ds_read_b128 v[108:111], v6 offset:1024
ds_read_b128 v[112:115], v6 offset:2048
ds_read_b128 v[116:119], v6 offset:3072
ds_read_b128 v[120:123], v6 offset:4096
ds_read_b128 v[124:127], v6 offset:5120
ds_read_b128 v[128:131], v6 offset:6144
ds_read_b128 v[132:135], v6 offset:7168
s_cmp_ge_u32 s30, 16
s_cbranch_scc1 P2_NOFIX
s_and_b32 s38, s30, 0xfffffffe
s_sub_u32 s38, 16, s38
s_nop 7
s_cmp_le_u32 s38, 0
s_cbranch_scc1 P2_NOFIX
v_mov_b32 v32, 0xf149f2ca
v_mov_b32 v33, 0xf149f2ca
v_mov_b32 v34, 0xf149f2ca
v_mov_b32 v35, 0xf149f2ca
s_cmp_le_u32 s38, 1
s_cbranch_scc1 P2_NOFIX
v_mov_b32 v36, 0xf149f2ca
v_mov_b32 v37, 0xf149f2ca
v_mov_b32 v38, 0xf149f2ca
v_mov_b32 v39, 0xf149f2ca
s_cmp_le_u32 s38, 2
s_cbranch_scc1 P2_NOFIX
v_mov_b32 v40, 0xf149f2ca
v_mov_b32 v41, 0xf149f2ca
v_mov_b32 v42, 0xf149f2ca
v_mov_b32 v43, 0xf149f2ca
s_cmp_le_u32 s38, 3
s_cbranch_scc1 P2_NOFIX
v_mov_b32 v44, 0xf149f2ca
v_mov_b32 v45, 0xf149f2ca
v_mov_b32 v46, 0xf149f2ca
v_mov_b32 v47, 0xf149f2ca
s_cmp_le_u32 s38, 4
s_cbranch_scc1 P2_NOFIX
v_mov_b32 v48, 0xf149f2ca
v_mov_b32 v49, 0xf149f2ca
v_mov_b32 v50, 0xf149f2ca
v_mov_b32 v51, 0xf149f2ca
s_cmp_le_u32 s38, 5
s_cbranch_scc1 P2_NOFIX
v_mov_b32 v52, 0xf149f2ca
v_mov_b32 v53, 0xf149f2ca
v_mov_b32 v54, 0xf149f2ca
v_mov_b32 v55, 0xf149f2ca
s_cmp_le_u32 s38, 6
s_cbranch_scc1 P2_NOFIX
v_mov_b32 v56, 0xf149f2ca
v_mov_b32 v57, 0xf149f2ca
v_mov_b32 v58, 0xf149f2ca
v_mov_b32 v59, 0xf149f2ca
s_cmp_le_u32 s38, 7
s_cbranch_scc1 P2_NOFIX
v_mov_b32 v60, 0xf149f2ca
v_mov_b32 v61, 0xf149f2ca
v_mov_b32 v62, 0xf149f2ca
v_mov_b32 v63, 0xf149f2ca
s_cmp_le_u32 s38, 8
s_cbranch_scc1 P2_NOFIX
v_mov_b32 v64, 0xf149f2ca
v_mov_b32 v65, 0xf149f2ca
v_mov_b32 v66, 0xf149f2ca
v_mov_b32 v67, 0xf149f2ca
s_cmp_le_u32 s38, 9
s_cbranch_scc1 P2_NOFIX
v_mov_b32 v68, 0xf149f2ca
v_mov_b32 v69, 0xf149f2ca
v_mov_b32 v70, 0xf149f2ca
v_mov_b32 v71, 0xf149f2ca
s_cmp_le_u32 s38, 10
s_cbranch_scc1 P2_NOFIX
v_mov_b32 v72, 0xf149f2ca
v_mov_b32 v73, 0xf149f2ca
v_mov_b32 v74, 0xf149f2ca
v_mov_b32 v75, 0xf149f2ca
s_cmp_le_u32 s38, 11
s_cbranch_scc1 P2_NOFIX
v_mov_b32 v76, 0xf149f2ca
v_mov_b32 v77, 0xf149f2ca
v_mov_b32 v78, 0xf149f2ca
v_mov_b32 v79, 0xf149f2ca
s_cmp_le_u32 s38, 12
s_cbranch_scc1 P2_NOFIX
v_mov_b32 v80, 0xf149f2ca
v_mov_b32 v81, 0xf149f2ca
v_mov_b32 v82, 0xf149f2ca
v_mov_b32 v83, 0xf149f2ca
s_cmp_le_u32 s38, 13
s_cbranch_scc1 P2_NOFIX
v_mov_b32 v84, 0xf149f2ca
v_mov_b32 v85, 0xf149f2ca
v_mov_b32 v86, 0xf149f2ca
v_mov_b32 v87, 0xf149f2ca
s_cmp_le_u32 s38, 14
s_cbranch_scc1 P2_NOFIX
v_mov_b32 v88, 0xf149f2ca
v_mov_b32 v89, 0xf149f2ca
v_mov_b32 v90, 0xf149f2ca
v_mov_b32 v91, 0xf149f2ca
s_cmp_le_u32 s38, 15
s_cbranch_scc1 P2_NOFIX
v_mov_b32 v92, 0xf149f2ca
v_mov_b32 v93, 0xf149f2ca
v_mov_b32 v94, 0xf149f2ca
v_mov_b32 v95, 0xf149f2ca
P2_NOFIX:
s_nop 7
v_max3_f32 v28, v32, v33, v34
v_max3_f32 v29, v35, v36, v37
v_max3_f32 v28, v28, v38, v39
v_max3_f32 v29, v29, v40, v41
v_max3_f32 v28, v28, v42, v43
v_max3_f32 v29, v29, v44, v45
v_max3_f32 v28, v28, v46, v47
v_max3_f32 v29, v29, v48, v49
v_max3_f32 v28, v28, v50, v51
v_max3_f32 v29, v29, v52, v53
v_max3_f32 v28, v28, v54, v55
v_max3_f32 v29, v29, v56, v57
v_max3_f32 v28, v28, v58, v59
v_max3_f32 v29, v29, v60, v61
v_max3_f32 v28, v28, v62, v63
v_max3_f32 v29, v29, v64, v65
v_max3_f32 v28, v28, v66, v67
v_max3_f32 v29, v29, v68, v69
v_max3_f32 v28, v28, v70, v71
v_max3_f32 v29, v29, v72, v73
v_max3_f32 v28, v28, v74, v75
v_max3_f32 v29, v29, v76, v77
v_max3_f32 v28, v28, v78, v79
v_max3_f32 v29, v29, v80, v81
v_max3_f32 v28, v28, v82, v83
v_max3_f32 v29, v29, v84, v85
v_max3_f32 v28, v28, v86, v87
v_max3_f32 v29, v29, v88, v89
v_max3_f32 v28, v28, v90, v91
v_max3_f32 v29, v29, v92, v93
v_max3_f32 v28, v28, v94, v95
v_max3_f32 v29, v29, v96, v97
v_max3_f32 v28, v28, v98, v99
v_max3_f32 v29, v29, v100, v101
v_max3_f32 v28, v28, v102, v103
v_max_f32 v28, v28, v29
v_mov_b32 v29, v28
s_nop 1
v_permlane32_swap_b32 v28, v29
s_nop 0
v_max_f32 v28, v28, v29
v_mov_b32 v29, v28
s_nop 1
v_permlane16_swap_b32 v28, v29
s_nop 0
v_max_f32 v28, v28, v29
v_sub_f32 v28, 0, v28
v_mov_b32 v29, v28
v_mov_b32 v136, 0
v_mov_b32 v137, 0
v_mov_b32 v138, 0
v_mov_b32 v139, 0
v_mov_b32 v140, 0
v_mov_b32 v141, 0
v_mov_b32 v142, 0
v_mov_b32 v143, 0
v_mov_b32 v20, 0
v_mov_b32 v24, 0x3f803f80
v_mov_b32 v21, 0
v_mov_b32 v25, 0x3f803f80
v_mov_b32 v22, 0
v_mov_b32 v26, 0x3f803f80
v_mov_b32 v23, 0
v_mov_b32 v27, 0x3f803f80
v_pk_add_f32 v[32:33], v[32:33], v[28:29]
v_pk_add_f32 v[34:35], v[34:35], v[28:29]
v_pk_add_f32 v[36:37], v[36:37], v[28:29]
v_pk_add_f32 v[38:39], v[38:39], v[28:29]
v_exp_f32 v32, v32
v_exp_f32 v33, v33
v_exp_f32 v34, v34
v_exp_f32 v35, v35
v_exp_f32 v36, v36
v_exp_f32 v37, v37
v_exp_f32 v38, v38
v_exp_f32 v39, v39
s_nop 0
v_cvt_pk_bf16_f32 v12, v32, v33
v_cvt_pk_bf16_f32 v13, v34, v35
v_cvt_pk_bf16_f32 v14, v36, v37
v_cvt_pk_bf16_f32 v15, v38, v39
s_waitcnt lgkmcnt(6)
s_nop 0
v_mfma_f32_16x16x32_bf16 v[136:139], v[104:107], v[12:15], v[136:139]
v_mfma_f32_16x16x32_bf16 v[140:143], v[108:111], v[12:15], v[140:143]
v_mfma_f32_16x16x32_bf16 v[20:23], v[24:27], v[12:15], v[20:23]
ds_read_b128 v[104:107], v6 offset:8192
ds_read_b128 v[108:111], v6 offset:9216
s_add_u32 m0, s44, 88064
s_add_u32 s45, s43, 6144
buffer_load_dwordx4 v4, s[20:23], s45 offen sc1 lds
v_pk_add_f32 v[40:41], v[40:41], v[28:29]
v_pk_add_f32 v[42:43], v[42:43], v[28:29]
v_pk_add_f32 v[44:45], v[44:45], v[28:29]
v_pk_add_f32 v[46:47], v[46:47], v[28:29]
v_exp_f32 v40, v40
v_exp_f32 v41, v41
v_exp_f32 v42, v42
v_exp_f32 v43, v43
v_exp_f32 v44, v44
v_exp_f32 v45, v45
v_exp_f32 v46, v46
v_exp_f32 v47, v47
s_nop 0
v_cvt_pk_bf16_f32 v16, v40, v41
v_cvt_pk_bf16_f32 v17, v42, v43
v_cvt_pk_bf16_f32 v18, v44, v45
v_cvt_pk_bf16_f32 v19, v46, v47
s_waitcnt lgkmcnt(6)
s_nop 0
v_mfma_f32_16x16x32_bf16 v[136:139], v[112:115], v[16:19], v[136:139]
v_mfma_f32_16x16x32_bf16 v[140:143], v[116:119], v[16:19], v[140:143]
v_mfma_f32_16x16x32_bf16 v[20:23], v[24:27], v[16:19], v[20:23]
ds_read_b128 v[112:115], v6 offset:10240
ds_read_b128 v[116:119], v6 offset:11264
s_add_u32 s45, s47, 0
buffer_load_dwordx4 v[144:147], v4, s[20:23], s45 offen sc1
v_pk_add_f32 v[48:49], v[48:49], v[28:29]
v_pk_add_f32 v[50:51], v[50:51], v[28:29]
v_pk_add_f32 v[52:53], v[52:53], v[28:29]
v_pk_add_f32 v[54:55], v[54:55], v[28:29]
v_exp_f32 v48, v48
v_exp_f32 v49, v49
v_exp_f32 v50, v50
v_exp_f32 v51, v51
v_exp_f32 v52, v52
v_exp_f32 v53, v53
v_exp_f32 v54, v54
v_exp_f32 v55, v55
s_nop 0
v_cvt_pk_bf16_f32 v12, v48, v49
v_cvt_pk_bf16_f32 v13, v50, v51
v_cvt_pk_bf16_f32 v14, v52, v53
v_cvt_pk_bf16_f32 v15, v54, v55
s_waitcnt lgkmcnt(6)
s_nop 0
v_mfma_f32_16x16x32_bf16 v[136:139], v[120:123], v[12:15], v[136:139]
v_mfma_f32_16x16x32_bf16 v[140:143], v[124:127], v[12:15], v[140:143]
v_mfma_f32_16x16x32_bf16 v[20:23], v[24:27], v[12:15], v[20:23]
ds_read_b128 v[120:123], v6 offset:12288
ds_read_b128 v[124:127], v6 offset:13312
s_add_u32 s45, s47, 1024
buffer_load_dwordx4 v[148:151], v4, s[20:23], s45 offen sc1
v_pk_add_f32 v[56:57], v[56:57], v[28:29]
v_pk_add_f32 v[58:59], v[58:59], v[28:29]
v_pk_add_f32 v[60:61], v[60:61], v[28:29]
v_pk_add_f32 v[62:63], v[62:63], v[28:29]
v_exp_f32 v56, v56
v_exp_f32 v57, v57
v_exp_f32 v58, v58
v_exp_f32 v59, v59
v_exp_f32 v60, v60
v_exp_f32 v61, v61
v_exp_f32 v62, v62
v_exp_f32 v63, v63
s_nop 0
v_cvt_pk_bf16_f32 v16, v56, v57
v_cvt_pk_bf16_f32 v17, v58, v59
v_cvt_pk_bf16_f32 v18, v60, v61
v_cvt_pk_bf16_f32 v19, v62, v63
s_waitcnt lgkmcnt(6)
s_nop 0
v_mfma_f32_16x16x32_bf16 v[136:139], v[128:131], v[16:19], v[136:139]
v_mfma_f32_16x16x32_bf16 v[140:143], v[132:135], v[16:19], v[140:143]
v_mfma_f32_16x16x32_bf16 v[20:23], v[24:27], v[16:19], v[20:23]
ds_read_b128 v[128:131], v6 offset:14336
ds_read_b128 v[132:135], v6 offset:15360
s_add_u32 s45, s47, 2048
buffer_load_dwordx4 v[152:155], v4, s[20:23], s45 offen sc1
v_pk_add_f32 v[64:65], v[64:65], v[28:29]
v_pk_add_f32 v[66:67], v[66:67], v[28:29]
v_pk_add_f32 v[68:69], v[68:69], v[28:29]
v_pk_add_f32 v[70:71], v[70:71], v[28:29]
v_exp_f32 v64, v64
v_exp_f32 v65, v65
v_exp_f32 v66, v66
v_exp_f32 v67, v67
v_exp_f32 v68, v68
v_exp_f32 v69, v69
v_exp_f32 v70, v70
v_exp_f32 v71, v71
s_nop 0
v_cvt_pk_bf16_f32 v12, v64, v65
v_cvt_pk_bf16_f32 v13, v66, v67
v_cvt_pk_bf16_f32 v14, v68, v69
v_cvt_pk_bf16_f32 v15, v70, v71
s_waitcnt lgkmcnt(6)
s_nop 0
v_mfma_f32_16x16x32_bf16 v[136:139], v[104:107], v[12:15], v[136:139]
v_mfma_f32_16x16x32_bf16 v[140:143], v[108:111], v[12:15], v[140:143]
v_mfma_f32_16x16x32_bf16 v[20:23], v[24:27], v[12:15], v[20:23]
ds_read_b128 v[104:107], v6 offset:16384
ds_read_b128 v[108:111], v6 offset:17408
s_add_u32 s45, s47, 3072
buffer_load_dwordx4 v[156:159], v4, s[20:23], s45 offen sc1
v_pk_add_f32 v[72:73], v[72:73], v[28:29]
v_pk_add_f32 v[74:75], v[74:75], v[28:29]
v_pk_add_f32 v[76:77], v[76:77], v[28:29]
v_pk_add_f32 v[78:79], v[78:79], v[28:29]
v_exp_f32 v72, v72
v_exp_f32 v73, v73
v_exp_f32 v74, v74
v_exp_f32 v75, v75
v_exp_f32 v76, v76
v_exp_f32 v77, v77
v_exp_f32 v78, v78
v_exp_f32 v79, v79
s_nop 0
v_cvt_pk_bf16_f32 v16, v72, v73
v_cvt_pk_bf16_f32 v17, v74, v75
v_cvt_pk_bf16_f32 v18, v76, v77
v_cvt_pk_bf16_f32 v19, v78, v79
s_waitcnt lgkmcnt(6)
s_nop 0
v_mfma_f32_16x16x32_bf16 v[136:139], v[112:115], v[16:19], v[136:139]
v_mfma_f32_16x16x32_bf16 v[140:143], v[116:119], v[16:19], v[140:143]
v_mfma_f32_16x16x32_bf16 v[20:23], v[24:27], v[16:19], v[20:23]
s_add_u32 s45, s47, 4096
buffer_load_dwordx4 v[160:163], v4, s[20:23], s45 offen sc1
v_pk_add_f32 v[80:81], v[80:81], v[28:29]
v_pk_add_f32 v[82:83], v[82:83], v[28:29]
v_pk_add_f32 v[84:85], v[84:85], v[28:29]
v_pk_add_f32 v[86:87], v[86:87], v[28:29]
v_exp_f32 v80, v80
v_exp_f32 v81, v81
v_exp_f32 v82, v82
v_exp_f32 v83, v83
v_exp_f32 v84, v84
v_exp_f32 v85, v85
v_exp_f32 v86, v86
v_exp_f32 v87, v87
s_nop 0
v_cvt_pk_bf16_f32 v12, v80, v81
v_cvt_pk_bf16_f32 v13, v82, v83
v_cvt_pk_bf16_f32 v14, v84, v85
v_cvt_pk_bf16_f32 v15, v86, v87
s_waitcnt lgkmcnt(4)
s_nop 0
v_mfma_f32_16x16x32_bf16 v[136:139], v[120:123], v[12:15], v[136:139]
v_mfma_f32_16x16x32_bf16 v[140:143], v[124:127], v[12:15], v[140:143]
v_mfma_f32_16x16x32_bf16 v[20:23], v[24:27], v[12:15], v[20:23]
s_add_u32 s45, s47, 5120
buffer_load_dwordx4 v[164:167], v4, s[20:23], s45 offen sc1
v_pk_add_f32 v[88:89], v[88:89], v[28:29]
v_pk_add_f32 v[90:91], v[90:91], v[28:29]
v_pk_add_f32 v[92:93], v[92:93], v[28:29]
v_pk_add_f32 v[94:95], v[94:95], v[28:29]
v_exp_f32 v88, v88
v_exp_f32 v89, v89
v_exp_f32 v90, v90
v_exp_f32 v91, v91
v_exp_f32 v92, v92
v_exp_f32 v93, v93
v_exp_f32 v94, v94
v_exp_f32 v95, v95
s_nop 0
v_cvt_pk_bf16_f32 v16, v88, v89
v_cvt_pk_bf16_f32 v17, v90, v91
v_cvt_pk_bf16_f32 v18, v92, v93
v_cvt_pk_bf16_f32 v19, v94, v95
s_waitcnt lgkmcnt(2)
s_nop 0
v_mfma_f32_16x16x32_bf16 v[136:139], v[128:131], v[16:19], v[136:139]
v_mfma_f32_16x16x32_bf16 v[140:143], v[132:135], v[16:19], v[140:143]
v_mfma_f32_16x16x32_bf16 v[20:23], v[24:27], v[16:19], v[20:23]
v_pk_add_f32 v[96:97], v[96:97], v[28:29]
v_pk_add_f32 v[98:99], v[98:99], v[28:29]
v_pk_add_f32 v[100:101], v[100:101], v[28:29]
v_pk_add_f32 v[102:103], v[102:103], v[28:29]
v_exp_f32 v96, v96
v_exp_f32 v97, v97
v_exp_f32 v98, v98
v_exp_f32 v99, v99
v_exp_f32 v100, v100
v_exp_f32 v101, v101
v_exp_f32 v102, v102
v_exp_f32 v103, v103
s_nop 0
v_cvt_pk_bf16_f32 v12, v96, v97
v_cvt_pk_bf16_f32 v13, v98, v99
v_cvt_pk_bf16_f32 v14, v100, v101
v_cvt_pk_bf16_f32 v15, v102, v103
s_waitcnt lgkmcnt(0)
s_nop 0
v_mfma_f32_16x16x32_bf16 v[136:139], v[104:107], v[12:15], v[136:139]
v_mfma_f32_16x16x32_bf16 v[140:143], v[108:111], v[12:15], v[140:143]
v_mfma_f32_16x16x32_bf16 v[20:23], v[24:27], v[12:15], v[20:23]
s_nop 7
v_rcp_f32 v28, v20
s_nop 0
v_mul_f32 v136, v136, v28
v_mul_f32 v137, v137, v28
v_mul_f32 v138, v138, v28
v_mul_f32 v139, v139, v28
v_mul_f32 v140, v140, v28
v_mul_f32 v141, v141, v28
v_mul_f32 v142, v142, v28
v_mul_f32 v143, v143, v28
v_cvt_pk_bf16_f32 v32, v136, v137
v_cvt_pk_bf16_f32 v33, v138, v139
v_cvt_pk_bf16_f32 v34, v140, v141
v_cvt_pk_bf16_f32 v35, v142, v143
buffer_store_dwordx2 v[32:33], v30, s[20:23], s49 offen sc1
s_mov_b32 exec_hi, 0x0000ffff
buffer_store_dwordx2 v[34:35], v30, s[20:23], s49 offen offset:512 sc1
s_mov_b64 exec, -1
s_cmp_eq_u32 s25, 7
s_cbranch_scc1 K_J7
s_waitcnt vmcnt(0)
s_barrier
s_cmp_lg_u32 s26, 0
s_cbranch_scc1 WNP_P2
v_mov_b32 v6, s58
v_mov_b32 v7, s59
s_lshl_b32 s50, s24, 7
s_lshl_b32 s51, s25, 4
s_add_u32 s50, s50, s51
s_add_u32 s50, s50, 4096
v_mov_b32 v5, 0
v_mov_b32 v8, s99
v_mov_b32 v9, s99
s_mov_b64 exec, 1
buffer_store_dwordx4 v[6:9], v5, s[20:23], s50 offen sc1
s_mov_b64 exec, -1
WNP_P2:
s_min_u32 s46, s25, 6
s_lshl_b32 s47, s46, 3
s_add_u32 s47, s47, s26
s_mul_i32 s47, s47, 28672
s_add_u32 s47, s47, 19398656
s_add_u32 s45, s47, 6144
buffer_load_dwordx4 v[168:171], v4, s[20:23], s45 offen sc1
s_add_u32 s45, s47, 7168
buffer_load_dwordx4 v[172:175], v4, s[20:23], s45 offen sc1
s_add_u32 s45, s47, 8192
buffer_load_dwordx4 v[176:179], v4, s[20:23], s45 offen sc1
s_add_u32 s45, s47, 9216
buffer_load_dwordx4 v[180:183], v4, s[20:23], s45 offen sc1
s_add_u32 s45, s47, 10240
buffer_load_dwordx4 v[184:187], v4, s[20:23], s45 offen sc1
s_add_u32 s45, s47, 11264
buffer_load_dwordx4 v[188:191], v4, s[20:23], s45 offen sc1
s_add_u32 s45, s47, 12288
buffer_load_dwordx4 v[192:195], v4, s[20:23], s45 offen sc1
s_add_u32 s45, s47, 13312
buffer_load_dwordx4 v[196:199], v4, s[20:23], s45 offen sc1
s_add_u32 s45, s47, 14336
buffer_load_dwordx4 v[200:203], v4, s[20:23], s45 offen sc1
s_add_u32 s45, s47, 15360
buffer_load_dwordx4 v[204:207], v4, s[20:23], s45 offen sc1
s_add_u32 s45, s47, 16384
buffer_load_dwordx4 v[208:211], v4, s[20:23], s45 offen sc1
s_add_u32 s45, s47, 17408
buffer_load_dwordx4 v[212:215], v4, s[20:23], s45 offen sc1
s_add_u32 s45, s47, 18432
buffer_load_dwordx4 v[216:219], v4, s[20:23], s45 offen sc1
s_add_u32 s45, s47, 19456
buffer_load_dwordx4 v[220:223], v4, s[20:23], s45 offen sc1
s_cmp_lg_u32 s26, 0
s_cbranch_scc1 WNX_P2
s_lshl_b32 s50, s24, 7
s_add_u32 s50, s50, 4096
s_mov_b32 s52, 255
s_mov_b32 s53, 0
s_mov_b32 s51, 0
buffer_load_dwordx4 v[112:115], v4, s[20:23], s50 offen sc1
POLL_S2:
s_waitcnt vmcnt(0)
v_cmp_eq_u32 s[54:55], s58, v112
v_cmp_eq_u32 s[56:57], s59, v113
v_cmp_eq_u32 s[44:45], s58, v114
v_cmp_eq_u32 s[46:47], s59, v115
s_add_u32 s51, s51, 1
s_and_b64 s[54:55], s[54:55], s[56:57]
s_and_b64 s[44:45], s[44:45], s[46:47]
s_or_b64 s[44:45], s[44:45], 255
s_and_b64 s[54:55], s[54:55], s[44:45]
s_and_b64 s[54:55], s[54:55], s[52:53]
s_cmp_eq_u64 s[54:55], s[52:53]
s_cbranch_scc1 POLLX_S2
buffer_load_dwordx4 v[112:115], v4, s[20:23], s50 offen sc1
s_cmp_lt_u32 s51, 16384
s_cbranch_scc1 POLL_S2
POLLX_S2:
v_cmp_eq_u32 s[54:55], s99, v114
s_nop 3
s_and_b32 s54, s54, 0xff
s_cmp_eq_u32 s54, 0xff
s_cselect_b32 s93, 1, 0
WNX_P2:
s_barrier
s_lshr_b32 s27, s26, 1
s_and_b32 s28, s26, 1
s_lshl_b32 s30, s24, 2
s_add_u32 s30, s30, s27
s_mul_i32 s33, s24, 57344
s_mul_i32 s34, s26, 7168
s_add_u32 s33, s33, s34
s_add_u32 s33, s33, 7340032
s_add_u32 m0, s34, 0
s_add_u32 s35, s33, 0
buffer_load_dwordx4 v4, s[20:23], s35 offen sc1 lds
s_add_u32 m0, s34, 1024
s_add_u32 s35, s33, 1024
buffer_load_dwordx4 v4, s[20:23], s35 offen sc1 lds
s_add_u32 m0, s34, 2048
s_add_u32 s35, s33, 2048
buffer_load_dwordx4 v4, s[20:23], s35 offen sc1 lds
s_add_u32 m0, s34, 3072
s_add_u32 s35, s33, 3072
buffer_load_dwordx4 v4, s[20:23], s35 offen sc1 lds
s_add_u32 m0, s34, 4096
s_add_u32 s35, s33, 4096
buffer_load_dwordx4 v4, s[20:23], s35 offen sc1 lds
s_add_u32 m0, s34, 5120
s_add_u32 s35, s33, 5120
buffer_load_dwordx4 v4, s[20:23], s35 offen sc1 lds
s_add_u32 m0, s34, 6144
s_add_u32 s35, s33, 6144
buffer_load_dwordx4 v4, s[20:23], s35 offen sc1 lds
v_mov_b32 v32, 0x3f803f80
v_mov_b32 v33, 0x3f803f80
v_mov_b32 v34, 0x3f803f80
v_mov_b32 v35, 0x3f803f80
v_mov_b32 v48, 0
v_mov_b32 v49, 0
v_mov_b32 v50, 0
v_mov_b32 v51, 0
v_mov_b32 v52, 0
v_mov_b32 v53, 0
v_mov_b32 v54, 0
v_mov_b32 v55, 0
v_mov_b32 v56, 0
v_mov_b32 v57, 0
v_mov_b32 v58, 0
v_mov_b32 v59, 0
v_mov_b32 v60, 0
v_mov_b32 v61, 0
v_mov_b32 v62, 0
v_mov_b32 v63, 0
s_mul_i32 s34, s28, 28672
s_add_u32 s34, s34, 81920
v_add_u32 v6, s34, v4
s_mul_i32 s34, s27, 14336
s_mul_i32 s35, s28, 7168
s_add_u32 s34, s34, s35
v_lshlrev_b32 v5, 8, v3
v_lshlrev_b32 v7, 3, v2
v_add_u32 v5, v5, v7
v_add_u32 v5, s34, v5
s_waitcnt vmcnt(0)
s_barrier
ds_read_b128 v[64:67], v6 offset:0
ds_read_b128 v[68:71], v6 offset:1024
ds_read_b128 v[72:75], v6 offset:2048
ds_read_b64 v[80:81], v5 offset:0
ds_read_b64 v[82:83], v5 offset:128
ds_read_b64 v[84:85], v5 offset:1024
ds_read_b64 v[86:87], v5 offset:1152
ds_read_b64 v[88:89], v5 offset:2048
ds_read_b64 v[90:91], v5 offset:2176
ds_read_b64 v[92:93], v5 offset:3072
ds_read_b64 v[94:95], v5 offset:3200
ds_read_b64 v[96:97], v5 offset:4096
ds_read_b64 v[98:99], v5 offset:4224
ds_read_b64 v[100:101], v5 offset:5120
ds_read_b64 v[102:103], v5 offset:5248
s_waitcnt lgkmcnt(10)
ds_read_b64 v[104:105], v5 offset:6144
ds_read_b64 v[106:107], v5 offset:6272
ds_read_b128 v[76:79], v6 offset:3072
s_waitcnt lgkmcnt(3)
v_mfma_f32_16x16x32_bf16 v[48:51], v[64:67], v[80:83], v[48:51]
ds_read_b128 v[64:67], v6 offset:4096
s_waitcnt lgkmcnt(3)
v_mfma_f32_16x16x32_bf16 v[52:55], v[68:71], v[80:83], v[52:55]
ds_read_b128 v[68:71], v6 offset:5120
s_waitcnt lgkmcnt(3)
v_mfma_f32_16x16x32_bf16 v[56:59], v[72:75], v[80:83], v[56:59]
ds_read_b128 v[72:75], v6 offset:6144
s_waitcnt lgkmcnt(3)
v_mfma_f32_16x16x32_bf16 v[60:63], v[76:79], v[80:83], v[60:63]
ds_read_b128 v[76:79], v6 offset:7168
s_waitcnt lgkmcnt(3)
v_mfma_f32_16x16x32_bf16 v[48:51], v[64:67], v[84:87], v[48:51]
ds_read_b128 v[64:67], v6 offset:8192
s_waitcnt lgkmcnt(3)
v_mfma_f32_16x16x32_bf16 v[52:55], v[68:71], v[84:87], v[52:55]
ds_read_b128 v[68:71], v6 offset:9216
s_waitcnt lgkmcnt(3)
v_mfma_f32_16x16x32_bf16 v[56:59], v[72:75], v[84:87], v[56:59]
ds_read_b128 v[72:75], v6 offset:10240
s_waitcnt lgkmcnt(3)
v_mfma_f32_16x16x32_bf16 v[60:63], v[76:79], v[84:87], v[60:63]
ds_read_b128 v[76:79], v6 offset:11264
s_waitcnt lgkmcnt(3)
v_mfma_f32_16x16x32_bf16 v[48:51], v[64:67], v[88:91], v[48:51]
ds_read_b128 v[64:67], v6 offset:12288
s_waitcnt lgkmcnt(3)
v_mfma_f32_16x16x32_bf16 v[52:55], v[68:71], v[88:91], v[52:55]
ds_read_b128 v[68:71], v6 offset:13312
s_waitcnt lgkmcnt(3)
v_mfma_f32_16x16x32_bf16 v[56:59], v[72:75], v[88:91], v[56:59]
ds_read_b128 v[72:75], v6 offset:14336
s_waitcnt lgkmcnt(3)
v_mfma_f32_16x16x32_bf16 v[60:63], v[76:79], v[88:91], v[60:63]
ds_read_b128 v[76:79], v6 offset:15360
s_waitcnt lgkmcnt(3)
v_mfma_f32_16x16x32_bf16 v[48:51], v[64:67], v[92:95], v[48:51]
ds_read_b128 v[64:67], v6 offset:16384
s_waitcnt lgkmcnt(3)
v_mfma_f32_16x16x32_bf16 v[52:55], v[68:71], v[92:95], v[52:55]
ds_read_b128 v[68:71], v6 offset:17408
s_waitcnt lgkmcnt(3)
v_mfma_f32_16x16x32_bf16 v[56:59], v[72:75], v[92:95], v[56:59]
ds_read_b128 v[72:75], v6 offset:18432
s_waitcnt lgkmcnt(3)
v_mfma_f32_16x16x32_bf16 v[60:63], v[76:79], v[92:95], v[60:63]
ds_read_b128 v[76:79], v6 offset:19456
s_waitcnt lgkmcnt(3)
v_mfma_f32_16x16x32_bf16 v[48:51], v[64:67], v[96:99], v[48:51]
ds_read_b128 v[64:67], v6 offset:20480
s_waitcnt lgkmcnt(3)
v_mfma_f32_16x16x32_bf16 v[52:55], v[68:71], v[96:99], v[52:55]
ds_read_b128 v[68:71], v6 offset:21504
s_waitcnt lgkmcnt(3)
v_mfma_f32_16x16x32_bf16 v[56:59], v[72:75], v[96:99], v[56:59]
ds_read_b128 v[72:75], v6 offset:22528
s_waitcnt lgkmcnt(3)
v_mfma_f32_16x16x32_bf16 v[60:63], v[76:79], v[96:99], v[60:63]
ds_read_b128 v[76:79], v6 offset:23552
s_waitcnt lgkmcnt(3)
v_mfma_f32_16x16x32_bf16 v[48:51], v[64:67], v[100:103], v[48:51]
ds_read_b128 v[64:67], v6 offset:24576
s_waitcnt lgkmcnt(3)
v_mfma_f32_16x16x32_bf16 v[52:55], v[68:71], v[100:103], v[52:55]
ds_read_b128 v[68:71], v6 offset:25600
s_waitcnt lgkmcnt(3)
v_mfma_f32_16x16x32_bf16 v[56:59], v[72:75], v[100:103], v[56:59]
ds_read_b128 v[72:75], v6 offset:26624
s_waitcnt lgkmcnt(3)
v_mfma_f32_16x16x32_bf16 v[60:63], v[76:79], v[100:103], v[60:63]
ds_read_b128 v[76:79], v6 offset:27648
s_waitcnt lgkmcnt(3)
v_mfma_f32_16x16x32_bf16 v[48:51], v[64:67], v[104:107], v[48:51]
s_waitcnt lgkmcnt(2)
v_mfma_f32_16x16x32_bf16 v[52:55], v[68:71], v[104:107], v[52:55]
s_waitcnt lgkmcnt(1)
v_mfma_f32_16x16x32_bf16 v[56:59], v[72:75], v[104:107], v[56:59]
s_waitcnt lgkmcnt(0)
v_mfma_f32_16x16x32_bf16 v[60:63], v[76:79], v[104:107], v[60:63]
v_lshlrev_b32 v12, 16, v244
v_and_b32 v13, 0xffff0000, v244
v_lshlrev_b32 v14, 16, v245
v_and_b32 v15, 0xffff0000, v245
v_lshlrev_b32 v16, 16, v246
v_and_b32 v17, 0xffff0000, v246
v_lshlrev_b32 v18, 16, v247
v_and_b32 v19, 0xffff0000, v247
v_mov_b32 v44, v248
v_mov_b32 v45, v249
v_mov_b32 v46, v250
v_mov_b32 v47, v251
s_lshl_b32 s34, s26, 11
s_add_u32 s34, s34, 139264
v_add_u32 v6, s34, v4
s_xor_b32 s34, s34, 2048
v_add_u32 v7, s34, v4
s_cmp_eq_u32 s28, 1
s_cbranch_scc1 P3_KH1
ds_write_b128 v6, v[56:59]
ds_write_b128 v6, v[60:63] offset:1024
s_branch P3_X
P3_KH1:
ds_write_b128 v6, v[48:51]
ds_write_b128 v6, v[52:55] offset:1024
s_nop 1
v_mov_b32 v48, v56
v_mov_b32 v49, v57
v_mov_b32 v50, v58
v_mov_b32 v51, v59
v_mov_b32 v52, v60
v_mov_b32 v53, v61
v_mov_b32 v54, v62
v_mov_b32 v55, v63
P3_X:
v_lshlrev_b32 v72, 16, v240
v_and_b32 v73, 0xffff0000, v240
v_add_f32 v48, v48, v72
v_add_f32 v49, v49, v73
v_lshlrev_b32 v72, 16, v241
v_and_b32 v73, 0xffff0000, v241
v_add_f32 v50, v50, v72
v_add_f32 v51, v51, v73
v_lshlrev_b32 v72, 16, v242
v_and_b32 v73, 0xffff0000, v242
v_add_f32 v52, v52, v72
v_add_f32 v53, v53, v73
v_lshlrev_b32 v72, 16, v243
v_and_b32 v73, 0xffff0000, v243
v_add_f32 v54, v54, v72
v_add_f32 v55, v55, v73
s_waitcnt lgkmcnt(0)
s_barrier
ds_read_b128 v[64:67], v7
ds_read_b128 v[68:71], v7 offset:1024
s_mul_i32 s34, s30, 14336
s_lshl_b32 s35, s25, 11
s_add_u32 s34, s34, s35
s_lshl_b32 s35, s28, 10
s_add_u32 s34, s34, s35
s_add_u32 s34, s34, 9437184
s_mul_i32 s36, s30, 1792
s_lshl_b32 s35, s25, 8
s_add_u32 s36, s36, s35
s_lshl_b32 s35, s28, 7
s_add_u32 s36, s36, s35
s_add_u32 s36, s36, 23068672
v_lshlrev_b32 v5, 3, v2
s_waitcnt lgkmcnt(0)
v_add_f32 v48, v48, v64
v_add_f32 v49, v49, v65
v_add_f32 v50, v50, v66
v_add_f32 v51, v51, v67
v_add_f32 v52, v52, v68
v_add_f32 v53, v53, v69
v_add_f32 v54, v54, v70
v_add_f32 v55, v55, v71
v_cvt_pk_bf16_f32 v8, v48, v49
v_cvt_pk_bf16_f32 v9, v50, v51
v_cvt_pk_bf16_f32 v10, v52, v53
v_cvt_pk_bf16_f32 v11, v54, v55
buffer_store_dwordx4 v[8:11], v4, s[20:23], s34 offen sc1
v_mov_b32 v64, 0
v_mov_b32 v65, 0
v_dot2c_f32_bf16 v64, v8, v32
v_dot2c_f32_bf16 v65, v8, v8
v_dot2c_f32_bf16 v64, v9, v32
v_dot2c_f32_bf16 v65, v9, v9
v_dot2c_f32_bf16 v64, v10, v32
v_dot2c_f32_bf16 v65, v10, v10
v_dot2c_f32_bf16 v64, v11, v32
v_dot2c_f32_bf16 v65, v11, v11
s_nop 2
v_mov_b32 v66, v64
s_nop 1
v_permlane32_swap_b32 v64, v66
s_nop 0
v_add_f32 v64, v64, v66
v_mov_b32 v66, v64
s_nop 1
v_permlane16_swap_b32 v64, v66
s_nop 0
v_add_f32 v64, v64, v66
v_mov_b32 v67, v65
s_nop 1
v_permlane32_swap_b32 v65, v67
s_nop 0
v_add_f32 v65, v65, v67
v_mov_b32 v67, v65
s_nop 1
v_permlane16_swap_b32 v65, v67
s_nop 0
v_add_f32 v65, v65, v67
s_mov_b64 exec, 0xffff
buffer_store_dwordx2 v[64:65], v5, s[20:23], s36 offen sc1
s_mov_b64 exec, -1

v_mov_b32 v20, 0
v_mov_b32 v21, 0
v_mov_b32 v22, 0
v_mov_b32 v23, 0
v_mov_b32 v24, 0
v_mov_b32 v25, 0
v_mov_b32 v26, 0
v_mov_b32 v27, 0
s_waitcnt vmcnt(0)
s_barrier
s_cmp_lg_u32 s26, 0
s_cbranch_scc1 WNP_P3
v_mov_b32 v6, s58
v_mov_b32 v7, s59
s_lshl_b32 s50, s24, 7
s_lshl_b32 s51, s25, 3
s_add_u32 s50, s50, s51
s_add_u32 s50, s50, 8192
v_mov_b32 v5, 0
s_mov_b64 exec, 1
s_cmp_eq_u32 s93, 1
s_cbranch_scc0 FS2_SC
buffer_store_dwordx2 v[6:7], v5, s[20:23], s50 offen
s_branch FS2_X
FS2_SC:
buffer_store_dwordx2 v[6:7], v5, s[20:23], s50 offen sc1
FS2_X:
s_mov_b64 exec, -1
WNP_P3:
s_min_u32 s46, s25, 6
s_lshl_b32 s47, s46, 3
s_add_u32 s47, s47, s26
s_mul_i32 s47, s47, 28672
s_add_u32 s47, s47, 19398656
s_add_u32 s45, s47, 20480
buffer_load_dwordx4 v[224:227], v4, s[20:23], s45 offen sc1
s_add_u32 s45, s47, 21504
buffer_load_dwordx4 v[228:231], v4, s[20:23], s45 offen sc1
s_add_u32 s45, s47, 22528
buffer_load_dwordx4 v[232:235], v4, s[20:23], s45 offen sc1
s_add_u32 s45, s47, 23552
buffer_load_dwordx4 v[236:239], v4, s[20:23], s45 offen sc1
s_add_u32 s45, s47, 24576
buffer_load_dwordx4 v[240:243], v4, s[20:23], s45 offen sc1
s_add_u32 s45, s47, 25600
buffer_load_dwordx4 v[244:247], v4, s[20:23], s45 offen sc1
s_add_u32 s45, s47, 26624
buffer_load_dwordx4 v[248:251], v4, s[20:23], s45 offen sc1
s_add_u32 s45, s47, 27648
buffer_load_dwordx4 v[252:255], v4, s[20:23], s45 offen sc1
v_mfma_f32_16x16x32_bf16 v[20:23], v[144:147], v[32:35], v[20:23]
v_mfma_f32_16x16x32_bf16 v[24:27], v[148:151], v[32:35], v[24:27]
v_mfma_f32_16x16x32_bf16 v[20:23], v[152:155], v[32:35], v[20:23]
v_mfma_f32_16x16x32_bf16 v[24:27], v[156:159], v[32:35], v[24:27]
v_mfma_f32_16x16x32_bf16 v[20:23], v[160:163], v[32:35], v[20:23]
v_mfma_f32_16x16x32_bf16 v[24:27], v[164:167], v[32:35], v[24:27]
v_mfma_f32_16x16x32_bf16 v[20:23], v[168:171], v[32:35], v[20:23]
v_mfma_f32_16x16x32_bf16 v[24:27], v[172:175], v[32:35], v[24:27]
v_mfma_f32_16x16x32_bf16 v[20:23], v[176:179], v[32:35], v[20:23]
v_mfma_f32_16x16x32_bf16 v[24:27], v[180:183], v[32:35], v[24:27]
v_mfma_f32_16x16x32_bf16 v[20:23], v[184:187], v[32:35], v[20:23]
v_mfma_f32_16x16x32_bf16 v[24:27], v[188:191], v[32:35], v[24:27]
v_mfma_f32_16x16x32_bf16 v[20:23], v[192:195], v[32:35], v[20:23]
v_mfma_f32_16x16x32_bf16 v[24:27], v[196:199], v[32:35], v[24:27]
v_mfma_f32_16x16x32_bf16 v[20:23], v[200:203], v[32:35], v[20:23]
v_mfma_f32_16x16x32_bf16 v[24:27], v[204:207], v[32:35], v[24:27]
v_mfma_f32_16x16x32_bf16 v[20:23], v[208:211], v[32:35], v[20:23]
v_mfma_f32_16x16x32_bf16 v[24:27], v[212:215], v[32:35], v[24:27]
v_mfma_f32_16x16x32_bf16 v[20:23], v[216:219], v[32:35], v[20:23]
v_mfma_f32_16x16x32_bf16 v[24:27], v[220:223], v[32:35], v[24:27]
s_cmp_lg_u32 s26, 0
s_cbranch_scc1 WNX_P3
s_lshl_b32 s50, s24, 7
s_add_u32 s50, s50, 8192
s_mov_b32 s52, 15
s_mov_b32 s53, 0
s_mov_b32 s51, 0
buffer_load_dwordx4 v[112:115], v4, s[20:23], s50 offen sc1
POLL_S3:
s_waitcnt vmcnt(0)
v_cmp_eq_u32 s[54:55], s58, v112
v_cmp_eq_u32 s[56:57], s59, v113
v_cmp_eq_u32 s[44:45], s58, v114
v_cmp_eq_u32 s[46:47], s59, v115
s_add_u32 s51, s51, 1
s_and_b64 s[54:55], s[54:55], s[56:57]
s_and_b64 s[44:45], s[44:45], s[46:47]
s_or_b64 s[44:45], s[44:45], 248
s_and_b64 s[54:55], s[54:55], s[44:45]
s_and_b64 s[54:55], s[54:55], s[52:53]
s_cmp_eq_u64 s[54:55], s[52:53]
s_cbranch_scc1 POLLX_S3
buffer_load_dwordx4 v[112:115], v4, s[20:23], s50 offen sc1
s_cmp_lt_u32 s51, 16384
s_cbranch_scc1 POLL_S3
POLLX_S3:
s_lshl_b32 s50, s24, 10
s_add_u32 s50, s50, 65536
s_mov_b32 s52, 0
s_mov_b32 s53, 1048560
s_mov_b32 s51, 0
buffer_load_dwordx4 v[112:115], v4, s[20:23], s50 offen sc1
POLL_R2:
s_waitcnt vmcnt(0)
v_cmp_eq_u32 s[54:55], s58, v112
v_cmp_eq_u32 s[56:57], s59, v113
v_cmp_eq_u32 s[44:45], s58, v114
v_cmp_eq_u32 s[46:47], s59, v115
s_add_u32 s51, s51, 1
s_and_b64 s[54:55], s[54:55], s[56:57]
s_and_b64 s[44:45], s[44:45], s[46:47]
s_and_b64 s[54:55], s[54:55], s[44:45]
s_and_b64 s[54:55], s[54:55], s[52:53]
s_cmp_eq_u64 s[54:55], s[52:53]
s_cbranch_scc1 POLLX_R2
buffer_load_dwordx4 v[112:115], v4, s[20:23], s50 offen sc1
s_cmp_lt_u32 s51, 16384
s_cbranch_scc1 POLL_R2
POLLX_R2:
WNX_P3:
s_barrier
s_mul_i32 s31, s24, 57344
s_mul_i32 s32, s26, 7168
s_add_u32 s31, s31, s32
s_add_u32 s31, s31, 9437184
s_add_u32 m0, s32, 0
s_add_u32 s33, s31, 0
buffer_load_dwordx4 v4, s[20:23], s33 offen sc1 lds
s_add_u32 m0, s32, 1024
s_add_u32 s33, s31, 1024
buffer_load_dwordx4 v4, s[20:23], s33 offen sc1 lds
s_add_u32 m0, s32, 2048
s_add_u32 s33, s31, 2048
buffer_load_dwordx4 v4, s[20:23], s33 offen sc1 lds
s_add_u32 m0, s32, 3072
s_add_u32 s33, s31, 3072
buffer_load_dwordx4 v4, s[20:23], s33 offen sc1 lds
s_add_u32 m0, s32, 4096
s_add_u32 s33, s31, 4096
buffer_load_dwordx4 v4, s[20:23], s33 offen sc1 lds
s_add_u32 m0, s32, 5120
s_add_u32 s33, s31, 5120
buffer_load_dwordx4 v4, s[20:23], s33 offen sc1 lds
s_add_u32 m0, s32, 6144
s_add_u32 s33, s31, 6144
buffer_load_dwordx4 v4, s[20:23], s33 offen sc1 lds
s_and_b32 s27, s26, 3
s_lshl_b32 s33, s24, 2
s_add_u32 s33, s33, s27
s_mul_i32 s33, s33, 1792
s_add_u32 s33, s33, 23068672
v_lshlrev_b32 v5, 7, v3
v_lshlrev_b32 v6, 3, v2
v_add_u32 v5, v5, v6
buffer_load_dwordx2 v[112:113], v5, s[20:23], s33 offen offset:0 sc1
buffer_load_dwordx2 v[114:115], v5, s[20:23], s33 offen offset:512 sc1
buffer_load_dwordx2 v[116:117], v5, s[20:23], s33 offen offset:1024 sc1
v_mov_b32 v118, 0
v_mov_b32 v119, 0
s_mov_b32 exec_hi, 0
buffer_load_dwordx2 v[118:119], v5, s[20:23], s33 offen offset:1536 sc1
s_mov_b32 exec_hi, -1
v_mov_b32 v48, 0
v_mov_b32 v49, 0
v_mov_b32 v50, 0
v_mov_b32 v51, 0
v_mov_b32 v52, 0
v_mov_b32 v53, 0
v_mov_b32 v54, 0
v_mov_b32 v55, 0
v_mov_b32 v56, 0
v_mov_b32 v57, 0
v_mov_b32 v58, 0
v_mov_b32 v59, 0
v_mov_b32 v60, 0
v_mov_b32 v61, 0
v_mov_b32 v62, 0
v_mov_b32 v63, 0
v_mov_b32 v64, 0
v_mov_b32 v65, 0
v_mov_b32 v66, 0
v_mov_b32 v67, 0
v_mov_b32 v68, 0
v_mov_b32 v69, 0
v_mov_b32 v70, 0
v_mov_b32 v71, 0
v_mov_b32 v72, 0
v_mov_b32 v73, 0
v_mov_b32 v74, 0
v_mov_b32 v75, 0
v_mov_b32 v76, 0
v_mov_b32 v77, 0
v_mov_b32 v78, 0
v_mov_b32 v79, 0
s_waitcnt vmcnt(0)
v_add_f32 v112, v112, v114
v_add_f32 v116, v116, v118
v_add_f32 v112, v112, v116
v_add_f32 v113, v113, v115
v_add_f32 v117, v117, v119
v_add_f32 v113, v113, v117
v_mov_b32 v120, v112
s_nop 1
v_permlane32_swap_b32 v112, v120
s_nop 0
v_add_f32 v112, v112, v120
v_mov_b32 v120, v112
s_nop 1
v_permlane16_swap_b32 v112, v120
s_nop 0
v_add_f32 v112, v112, v120
v_mov_b32 v121, v113
s_nop 1
v_permlane32_swap_b32 v113, v121
s_nop 0
v_add_f32 v113, v113, v121
v_mov_b32 v121, v113
s_nop 1
v_permlane16_swap_b32 v113, v121
s_nop 0
v_add_f32 v113, v113, v121
v_mul_f32 v120, 0x3b124925, v112
v_mul_f32 v121, 0x3b124925, v113
v_fma_f32 v121, -v120, v120, v121
v_max_f32 v121, 0, v121
v_add_f32 v121, 0x3727c5ac, v121
v_rsq_f32 v122, v121
s_nop 0
v_mul_f32 v123, v120, v122
v_sub_f32 v123, 0, v123
s_lshl_b32 s33, s27, 7
s_add_u32 s33, s33, 57344
v_lshlrev_b32 v5, 3, v2
v_add_u32 v5, s33, v5
ds_write_b64 v5, v[122:123]
s_mul_i32 s48, s25, 229376
s_mul_i32 s49, s26, 28672
s_add_u32 s48, s48, s49
s_add_u32 s48, s48, 21102592
s_waitcnt lgkmcnt(0)
s_barrier
ds_read_b128 v[80:83], v4 offset:0
ds_read_b128 v[84:87], v4 offset:14336
ds_read_b128 v[88:91], v4 offset:28672
ds_read_b128 v[92:95], v4 offset:43008
s_waitcnt lgkmcnt(0)
v_mfma_f32_16x16x32_bf16 v[48:51], v[144:147], v[80:83], v[48:51]
v_mfma_f32_16x16x32_bf16 v[56:59], v[144:147], v[84:87], v[56:59]
ds_read_b128 v[96:99], v4 offset:1024
v_mfma_f32_16x16x32_bf16 v[64:67], v[144:147], v[88:91], v[64:67]
v_mfma_f32_16x16x32_bf16 v[72:75], v[144:147], v[92:95], v[72:75]
ds_read_b128 v[100:103], v4 offset:15360
v_mfma_f32_16x16x32_bf16 v[52:55], v[148:151], v[80:83], v[52:55]
v_mfma_f32_16x16x32_bf16 v[60:63], v[148:151], v[84:87], v[60:63]
ds_read_b128 v[104:107], v4 offset:29696
v_mfma_f32_16x16x32_bf16 v[68:71], v[148:151], v[88:91], v[68:71]
v_mfma_f32_16x16x32_bf16 v[76:79], v[148:151], v[92:95], v[76:79]
ds_read_b128 v[108:111], v4 offset:44032
s_waitcnt lgkmcnt(0)
s_cmp_lt_u32 s26, 4
s_cbranch_scc0 P4_NA1
s_add_u32 s45, s48, 0
buffer_load_dwordx4 v[144:147], v4, s[20:23], s45 offen sc1
s_add_u32 s45, s48, 1024
buffer_load_dwordx4 v[148:151], v4, s[20:23], s45 offen sc1
P4_NA1:
v_mfma_f32_16x16x32_bf16 v[48:51], v[152:155], v[96:99], v[48:51]
v_mfma_f32_16x16x32_bf16 v[56:59], v[152:155], v[100:103], v[56:59]
ds_read_b128 v[80:83], v4 offset:2048
v_mfma_f32_16x16x32_bf16 v[64:67], v[152:155], v[104:107], v[64:67]
v_mfma_f32_16x16x32_bf16 v[72:75], v[152:155], v[108:111], v[72:75]
ds_read_b128 v[84:87], v4 offset:16384
v_mfma_f32_16x16x32_bf16 v[52:55], v[156:159], v[96:99], v[52:55]
v_mfma_f32_16x16x32_bf16 v[60:63], v[156:159], v[100:103], v[60:63]
ds_read_b128 v[88:91], v4 offset:30720
v_mfma_f32_16x16x32_bf16 v[68:71], v[156:159], v[104:107], v[68:71]
v_mfma_f32_16x16x32_bf16 v[76:79], v[156:159], v[108:111], v[76:79]
ds_read_b128 v[92:95], v4 offset:45056
s_cmp_lt_u32 s26, 4
s_cbranch_scc1 P4_NB1
s_add_u32 s45, s48, 0
buffer_load_dwordx4 v[144:147], v4, s[20:23], s45 offen sc1
s_add_u32 s45, s48, 1024
buffer_load_dwordx4 v[148:151], v4, s[20:23], s45 offen sc1
P4_NB1:
s_waitcnt lgkmcnt(0)
s_cmp_lt_u32 s26, 4
s_cbranch_scc0 P4_NA2
s_add_u32 s45, s48, 2048
buffer_load_dwordx4 v[152:155], v4, s[20:23], s45 offen sc1
s_add_u32 s45, s48, 3072
buffer_load_dwordx4 v[156:159], v4, s[20:23], s45 offen sc1
P4_NA2:
v_mfma_f32_16x16x32_bf16 v[48:51], v[160:163], v[80:83], v[48:51]
v_mfma_f32_16x16x32_bf16 v[56:59], v[160:163], v[84:87], v[56:59]
ds_read_b128 v[96:99], v4 offset:3072
v_mfma_f32_16x16x32_bf16 v[64:67], v[160:163], v[88:91], v[64:67]
v_mfma_f32_16x16x32_bf16 v[72:75], v[160:163], v[92:95], v[72:75]
ds_read_b128 v[100:103], v4 offset:17408
v_mfma_f32_16x16x32_bf16 v[52:55], v[164:167], v[80:83], v[52:55]
v_mfma_f32_16x16x32_bf16 v[60:63], v[164:167], v[84:87], v[60:63]
ds_read_b128 v[104:107], v4 offset:31744
v_mfma_f32_16x16x32_bf16 v[68:71], v[164:167], v[88:91], v[68:71]
v_mfma_f32_16x16x32_bf16 v[76:79], v[164:167], v[92:95], v[76:79]
ds_read_b128 v[108:111], v4 offset:46080
s_cmp_lt_u32 s26, 4
s_cbranch_scc1 P4_NB2
s_add_u32 s45, s48, 2048
buffer_load_dwordx4 v[152:155], v4, s[20:23], s45 offen sc1
s_add_u32 s45, s48, 3072
buffer_load_dwordx4 v[156:159], v4, s[20:23], s45 offen sc1
P4_NB2:
s_waitcnt lgkmcnt(0)
s_cmp_lt_u32 s26, 4
s_cbranch_scc0 P4_NA3
s_add_u32 s45, s48, 4096
buffer_load_dwordx4 v[160:163], v4, s[20:23], s45 offen sc1
s_add_u32 s45, s48, 5120
buffer_load_dwordx4 v[164:167], v4, s[20:23], s45 offen sc1
P4_NA3:
v_mfma_f32_16x16x32_bf16 v[48:51], v[168:171], v[96:99], v[48:51]
v_mfma_f32_16x16x32_bf16 v[56:59], v[168:171], v[100:103], v[56:59]
ds_read_b128 v[80:83], v4 offset:4096
v_mfma_f32_16x16x32_bf16 v[64:67], v[168:171], v[104:107], v[64:67]
v_mfma_f32_16x16x32_bf16 v[72:75], v[168:171], v[108:111], v[72:75]
ds_read_b128 v[84:87], v4 offset:18432
v_mfma_f32_16x16x32_bf16 v[52:55], v[172:175], v[96:99], v[52:55]
v_mfma_f32_16x16x32_bf16 v[60:63], v[172:175], v[100:103], v[60:63]
ds_read_b128 v[88:91], v4 offset:32768
v_mfma_f32_16x16x32_bf16 v[68:71], v[172:175], v[104:107], v[68:71]
v_mfma_f32_16x16x32_bf16 v[76:79], v[172:175], v[108:111], v[76:79]
ds_read_b128 v[92:95], v4 offset:47104
s_cmp_lt_u32 s26, 4
s_cbranch_scc1 P4_NB3
s_add_u32 s45, s48, 4096
buffer_load_dwordx4 v[160:163], v4, s[20:23], s45 offen sc1
s_add_u32 s45, s48, 5120
buffer_load_dwordx4 v[164:167], v4, s[20:23], s45 offen sc1
P4_NB3:
s_waitcnt lgkmcnt(0)
s_cmp_lt_u32 s26, 4
s_cbranch_scc0 P4_NA4
s_add_u32 s45, s48, 6144
buffer_load_dwordx4 v[168:171], v4, s[20:23], s45 offen sc1
s_add_u32 s45, s48, 7168
buffer_load_dwordx4 v[172:175], v4, s[20:23], s45 offen sc1
P4_NA4:
v_mfma_f32_16x16x32_bf16 v[48:51], v[176:179], v[80:83], v[48:51]
v_mfma_f32_16x16x32_bf16 v[56:59], v[176:179], v[84:87], v[56:59]
ds_read_b128 v[96:99], v4 offset:5120
v_mfma_f32_16x16x32_bf16 v[64:67], v[176:179], v[88:91], v[64:67]
v_mfma_f32_16x16x32_bf16 v[72:75], v[176:179], v[92:95], v[72:75]
ds_read_b128 v[100:103], v4 offset:19456
v_mfma_f32_16x16x32_bf16 v[52:55], v[180:183], v[80:83], v[52:55]
v_mfma_f32_16x16x32_bf16 v[60:63], v[180:183], v[84:87], v[60:63]
ds_read_b128 v[104:107], v4 offset:33792
v_mfma_f32_16x16x32_bf16 v[68:71], v[180:183], v[88:91], v[68:71]
v_mfma_f32_16x16x32_bf16 v[76:79], v[180:183], v[92:95], v[76:79]
ds_read_b128 v[108:111], v4 offset:48128
s_cmp_lt_u32 s26, 4
s_cbranch_scc1 P4_NB4
s_add_u32 s45, s48, 6144
buffer_load_dwordx4 v[168:171], v4, s[20:23], s45 offen sc1
s_add_u32 s45, s48, 7168
buffer_load_dwordx4 v[172:175], v4, s[20:23], s45 offen sc1
P4_NB4:
s_waitcnt lgkmcnt(0)
s_cmp_lt_u32 s26, 4
s_cbranch_scc0 P4_NA5
s_add_u32 s45, s48, 8192
buffer_load_dwordx4 v[176:179], v4, s[20:23], s45 offen sc1
s_add_u32 s45, s48, 9216
buffer_load_dwordx4 v[180:183], v4, s[20:23], s45 offen sc1
P4_NA5:
v_mfma_f32_16x16x32_bf16 v[48:51], v[184:187], v[96:99], v[48:51]
v_mfma_f32_16x16x32_bf16 v[56:59], v[184:187], v[100:103], v[56:59]
ds_read_b128 v[80:83], v4 offset:6144
v_mfma_f32_16x16x32_bf16 v[64:67], v[184:187], v[104:107], v[64:67]
v_mfma_f32_16x16x32_bf16 v[72:75], v[184:187], v[108:111], v[72:75]
ds_read_b128 v[84:87], v4 offset:20480
v_mfma_f32_16x16x32_bf16 v[52:55], v[188:191], v[96:99], v[52:55]
v_mfma_f32_16x16x32_bf16 v[60:63], v[188:191], v[100:103], v[60:63]
ds_read_b128 v[88:91], v4 offset:34816
v_mfma_f32_16x16x32_bf16 v[68:71], v[188:191], v[104:107], v[68:71]
v_mfma_f32_16x16x32_bf16 v[76:79], v[188:191], v[108:111], v[76:79]
ds_read_b128 v[92:95], v4 offset:49152
s_cmp_lt_u32 s26, 4
s_cbranch_scc1 P4_NB5
s_add_u32 s45, s48, 8192
buffer_load_dwordx4 v[176:179], v4, s[20:23], s45 offen sc1
s_add_u32 s45, s48, 9216
buffer_load_dwordx4 v[180:183], v4, s[20:23], s45 offen sc1
P4_NB5:
s_waitcnt lgkmcnt(0)
s_cmp_lt_u32 s26, 4
s_cbranch_scc0 P4_NA6
s_add_u32 s45, s48, 10240
buffer_load_dwordx4 v[184:187], v4, s[20:23], s45 offen sc1
s_add_u32 s45, s48, 11264
buffer_load_dwordx4 v[188:191], v4, s[20:23], s45 offen sc1
P4_NA6:
v_mfma_f32_16x16x32_bf16 v[48:51], v[192:195], v[80:83], v[48:51]
v_mfma_f32_16x16x32_bf16 v[56:59], v[192:195], v[84:87], v[56:59]
ds_read_b128 v[96:99], v4 offset:7168
v_mfma_f32_16x16x32_bf16 v[64:67], v[192:195], v[88:91], v[64:67]
v_mfma_f32_16x16x32_bf16 v[72:75], v[192:195], v[92:95], v[72:75]
ds_read_b128 v[100:103], v4 offset:21504
v_mfma_f32_16x16x32_bf16 v[52:55], v[196:199], v[80:83], v[52:55]
v_mfma_f32_16x16x32_bf16 v[60:63], v[196:199], v[84:87], v[60:63]
ds_read_b128 v[104:107], v4 offset:35840
v_mfma_f32_16x16x32_bf16 v[68:71], v[196:199], v[88:91], v[68:71]
v_mfma_f32_16x16x32_bf16 v[76:79], v[196:199], v[92:95], v[76:79]
ds_read_b128 v[108:111], v4 offset:50176
s_cmp_lt_u32 s26, 4
s_cbranch_scc1 P4_NB6
s_add_u32 s45, s48, 10240
buffer_load_dwordx4 v[184:187], v4, s[20:23], s45 offen sc1
s_add_u32 s45, s48, 11264
buffer_load_dwordx4 v[188:191], v4, s[20:23], s45 offen sc1
P4_NB6:
s_waitcnt lgkmcnt(0)
s_cmp_lt_u32 s26, 4
s_cbranch_scc0 P4_NA7
s_add_u32 s45, s48, 12288
buffer_load_dwordx4 v[192:195], v4, s[20:23], s45 offen sc1
s_add_u32 s45, s48, 13312
buffer_load_dwordx4 v[196:199], v4, s[20:23], s45 offen sc1
P4_NA7:
v_mfma_f32_16x16x32_bf16 v[48:51], v[200:203], v[96:99], v[48:51]
v_mfma_f32_16x16x32_bf16 v[56:59], v[200:203], v[100:103], v[56:59]
ds_read_b128 v[80:83], v4 offset:8192
v_mfma_f32_16x16x32_bf16 v[64:67], v[200:203], v[104:107], v[64:67]
v_mfma_f32_16x16x32_bf16 v[72:75], v[200:203], v[108:111], v[72:75]
ds_read_b128 v[84:87], v4 offset:22528
v_mfma_f32_16x16x32_bf16 v[52:55], v[204:207], v[96:99], v[52:55]
v_mfma_f32_16x16x32_bf16 v[60:63], v[204:207], v[100:103], v[60:63]
ds_read_b128 v[88:91], v4 offset:36864
v_mfma_f32_16x16x32_bf16 v[68:71], v[204:207], v[104:107], v[68:71]
v_mfma_f32_16x16x32_bf16 v[76:79], v[204:207], v[108:111], v[76:79]
ds_read_b128 v[92:95], v4 offset:51200
s_cmp_lt_u32 s26, 4
s_cbranch_scc1 P4_NB7
s_add_u32 s45, s48, 12288
buffer_load_dwordx4 v[192:195], v4, s[20:23], s45 offen sc1
s_add_u32 s45, s48, 13312
buffer_load_dwordx4 v[196:199], v4, s[20:23], s45 offen sc1
P4_NB7:
s_waitcnt lgkmcnt(0)
s_cmp_lt_u32 s26, 4
s_cbranch_scc0 P4_NA8
s_add_u32 s45, s48, 14336
buffer_load_dwordx4 v[200:203], v4, s[20:23], s45 offen sc1
s_add_u32 s45, s48, 15360
buffer_load_dwordx4 v[204:207], v4, s[20:23], s45 offen sc1
P4_NA8:
v_mfma_f32_16x16x32_bf16 v[48:51], v[208:211], v[80:83], v[48:51]
v_mfma_f32_16x16x32_bf16 v[56:59], v[208:211], v[84:87], v[56:59]
ds_read_b128 v[96:99], v4 offset:9216
v_mfma_f32_16x16x32_bf16 v[64:67], v[208:211], v[88:91], v[64:67]
v_mfma_f32_16x16x32_bf16 v[72:75], v[208:211], v[92:95], v[72:75]
ds_read_b128 v[100:103], v4 offset:23552
v_mfma_f32_16x16x32_bf16 v[52:55], v[212:215], v[80:83], v[52:55]
v_mfma_f32_16x16x32_bf16 v[60:63], v[212:215], v[84:87], v[60:63]
ds_read_b128 v[104:107], v4 offset:37888
v_mfma_f32_16x16x32_bf16 v[68:71], v[212:215], v[88:91], v[68:71]
v_mfma_f32_16x16x32_bf16 v[76:79], v[212:215], v[92:95], v[76:79]
ds_read_b128 v[108:111], v4 offset:52224
s_cmp_lt_u32 s26, 4
s_cbranch_scc1 P4_NB8
s_add_u32 s45, s48, 14336
buffer_load_dwordx4 v[200:203], v4, s[20:23], s45 offen sc1
s_add_u32 s45, s48, 15360
buffer_load_dwordx4 v[204:207], v4, s[20:23], s45 offen sc1
P4_NB8:
s_waitcnt lgkmcnt(0)
s_cmp_lt_u32 s26, 4
s_cbranch_scc0 P4_NA9
s_add_u32 s45, s48, 16384
buffer_load_dwordx4 v[208:211], v4, s[20:23], s45 offen sc1
s_add_u32 s45, s48, 17408
buffer_load_dwordx4 v[212:215], v4, s[20:23], s45 offen sc1
P4_NA9:
v_mfma_f32_16x16x32_bf16 v[48:51], v[216:219], v[96:99], v[48:51]
v_mfma_f32_16x16x32_bf16 v[56:59], v[216:219], v[100:103], v[56:59]
ds_read_b128 v[80:83], v4 offset:10240
v_mfma_f32_16x16x32_bf16 v[64:67], v[216:219], v[104:107], v[64:67]
v_mfma_f32_16x16x32_bf16 v[72:75], v[216:219], v[108:111], v[72:75]
ds_read_b128 v[84:87], v4 offset:24576
v_mfma_f32_16x16x32_bf16 v[52:55], v[220:223], v[96:99], v[52:55]
v_mfma_f32_16x16x32_bf16 v[60:63], v[220:223], v[100:103], v[60:63]
ds_read_b128 v[88:91], v4 offset:38912
v_mfma_f32_16x16x32_bf16 v[68:71], v[220:223], v[104:107], v[68:71]
v_mfma_f32_16x16x32_bf16 v[76:79], v[220:223], v[108:111], v[76:79]
ds_read_b128 v[92:95], v4 offset:53248
s_cmp_lt_u32 s26, 4
s_cbranch_scc1 P4_NB9
s_add_u32 s45, s48, 16384
buffer_load_dwordx4 v[208:211], v4, s[20:23], s45 offen sc1
s_add_u32 s45, s48, 17408
buffer_load_dwordx4 v[212:215], v4, s[20:23], s45 offen sc1
P4_NB9:
s_waitcnt lgkmcnt(0)
s_cmp_lt_u32 s26, 4
s_cbranch_scc0 P4_NA10
s_add_u32 s45, s48, 18432
buffer_load_dwordx4 v[216:219], v4, s[20:23], s45 offen sc1
s_add_u32 s45, s48, 19456
buffer_load_dwordx4 v[220:223], v4, s[20:23], s45 offen sc1
P4_NA10:
v_mfma_f32_16x16x32_bf16 v[48:51], v[224:227], v[80:83], v[48:51]
v_mfma_f32_16x16x32_bf16 v[56:59], v[224:227], v[84:87], v[56:59]
v_mfma_f32_16x16x32_bf16 v[64:67], v[224:227], v[88:91], v[64:67]
ds_read_b128 v[96:99], v4 offset:11264
v_mfma_f32_16x16x32_bf16 v[72:75], v[224:227], v[92:95], v[72:75]
v_mfma_f32_16x16x32_bf16 v[52:55], v[228:231], v[80:83], v[52:55]
ds_read_b128 v[100:103], v4 offset:25600
v_mfma_f32_16x16x32_bf16 v[60:63], v[228:231], v[84:87], v[60:63]
v_mfma_f32_16x16x32_bf16 v[68:71], v[228:231], v[88:91], v[68:71]
v_mfma_f32_16x16x32_bf16 v[76:79], v[228:231], v[92:95], v[76:79]
ds_read_b128 v[104:107], v4 offset:39936
v_mfma_f32_16x16x32_bf16 v[20:23], v[224:227], v[32:35], v[20:23]
v_mfma_f32_16x16x32_bf16 v[24:27], v[228:231], v[32:35], v[24:27]
ds_read_b128 v[108:111], v4 offset:54272
s_cmp_lt_u32 s26, 4
s_cbranch_scc1 P4_NB10
s_add_u32 s45, s48, 18432
buffer_load_dwordx4 v[216:219], v4, s[20:23], s45 offen sc1
s_add_u32 s45, s48, 19456
buffer_load_dwordx4 v[220:223], v4, s[20:23], s45 offen sc1
P4_NB10:
s_waitcnt lgkmcnt(0)
v_mfma_f32_16x16x32_bf16 v[48:51], v[232:235], v[96:99], v[48:51]
v_mfma_f32_16x16x32_bf16 v[56:59], v[232:235], v[100:103], v[56:59]
v_mfma_f32_16x16x32_bf16 v[64:67], v[232:235], v[104:107], v[64:67]
ds_read_b128 v[80:83], v4 offset:12288
v_mfma_f32_16x16x32_bf16 v[72:75], v[232:235], v[108:111], v[72:75]
v_mfma_f32_16x16x32_bf16 v[52:55], v[236:239], v[96:99], v[52:55]
ds_read_b128 v[84:87], v4 offset:26624
v_mfma_f32_16x16x32_bf16 v[60:63], v[236:239], v[100:103], v[60:63]
v_mfma_f32_16x16x32_bf16 v[68:71], v[236:239], v[104:107], v[68:71]
v_mfma_f32_16x16x32_bf16 v[76:79], v[236:239], v[108:111], v[76:79]
ds_read_b128 v[88:91], v4 offset:40960
v_mfma_f32_16x16x32_bf16 v[20:23], v[232:235], v[32:35], v[20:23]
v_mfma_f32_16x16x32_bf16 v[24:27], v[236:239], v[32:35], v[24:27]
ds_read_b128 v[92:95], v4 offset:55296
s_waitcnt lgkmcnt(0)
v_mfma_f32_16x16x32_bf16 v[48:51], v[240:243], v[80:83], v[48:51]
v_mfma_f32_16x16x32_bf16 v[56:59], v[240:243], v[84:87], v[56:59]
v_mfma_f32_16x16x32_bf16 v[64:67], v[240:243], v[88:91], v[64:67]
ds_read_b128 v[96:99], v4 offset:13312
v_mfma_f32_16x16x32_bf16 v[72:75], v[240:243], v[92:95], v[72:75]
v_mfma_f32_16x16x32_bf16 v[52:55], v[244:247], v[80:83], v[52:55]
ds_read_b128 v[100:103], v4 offset:27648
v_mfma_f32_16x16x32_bf16 v[60:63], v[244:247], v[84:87], v[60:63]
v_mfma_f32_16x16x32_bf16 v[68:71], v[244:247], v[88:91], v[68:71]
v_mfma_f32_16x16x32_bf16 v[76:79], v[244:247], v[92:95], v[76:79]
ds_read_b128 v[104:107], v4 offset:41984
v_mfma_f32_16x16x32_bf16 v[20:23], v[240:243], v[32:35], v[20:23]
v_mfma_f32_16x16x32_bf16 v[24:27], v[244:247], v[32:35], v[24:27]
ds_read_b128 v[108:111], v4 offset:56320
s_waitcnt lgkmcnt(0)
v_mfma_f32_16x16x32_bf16 v[48:51], v[248:251], v[96:99], v[48:51]
v_mfma_f32_16x16x32_bf16 v[56:59], v[248:251], v[100:103], v[56:59]
v_mfma_f32_16x16x32_bf16 v[64:67], v[248:251], v[104:107], v[64:67]
v_mfma_f32_16x16x32_bf16 v[72:75], v[248:251], v[108:111], v[72:75]
v_mfma_f32_16x16x32_bf16 v[52:55], v[252:255], v[96:99], v[52:55]
v_mfma_f32_16x16x32_bf16 v[60:63], v[252:255], v[100:103], v[60:63]
v_mfma_f32_16x16x32_bf16 v[68:71], v[252:255], v[104:107], v[68:71]
v_mfma_f32_16x16x32_bf16 v[76:79], v[252:255], v[108:111], v[76:79]
v_mfma_f32_16x16x32_bf16 v[20:23], v[248:251], v[32:35], v[20:23]
v_mfma_f32_16x16x32_bf16 v[24:27], v[252:255], v[32:35], v[24:27]
v_lshlrev_b32 v5, 3, v2
v_add_u32 v5, 57344, v5
ds_read_b64 v[112:113], v5 offset:0
ds_read_b64 v[114:115], v5 offset:128
ds_read_b64 v[116:117], v5 offset:256
ds_read_b64 v[118:119], v5 offset:384
s_lshl_b32 s33, s24, 2
s_mul_i32 s33, s33, 57344
s_lshl_b32 s34, s25, 13
s_add_u32 s33, s33, s34
s_lshl_b32 s34, s26, 10
s_add_u32 s33, s33, s34
s_add_u32 s33, s33, 11534336
s_mov_b32 s90, s33
s_waitcnt lgkmcnt(0)
s_nop 4
v_fma_f32 v80, v20, v113, v12
v_fma_f32 v81, v21, v113, v13
v_fma_f32 v82, v22, v113, v14
v_fma_f32 v83, v23, v113, v15
v_fma_f32 v80, v48, v112, v80
v_fma_f32 v81, v49, v112, v81
v_fma_f32 v82, v50, v112, v82
v_fma_f32 v83, v51, v112, v83
v_max_f32 v80, 0, v80
v_max_f32 v81, 0, v81
v_max_f32 v82, 0, v82
v_max_f32 v83, 0, v83
v_mul_f32 v80, v80, v80
v_mul_f32 v81, v81, v81
v_mul_f32 v82, v82, v82
v_mul_f32 v83, v83, v83
v_fma_f32 v84, v24, v113, v16
v_fma_f32 v85, v25, v113, v17
v_fma_f32 v86, v26, v113, v18
v_fma_f32 v87, v27, v113, v19
v_fma_f32 v84, v52, v112, v84
v_fma_f32 v85, v53, v112, v85
v_fma_f32 v86, v54, v112, v86
v_fma_f32 v87, v55, v112, v87
v_max_f32 v84, 0, v84
v_max_f32 v85, 0, v85
v_max_f32 v86, 0, v86
v_max_f32 v87, 0, v87
v_mul_f32 v84, v84, v84
v_mul_f32 v85, v85, v85
v_mul_f32 v86, v86, v86
v_mul_f32 v87, v87, v87
v_cvt_pk_bf16_f32 v48, v80, v81
v_cvt_pk_bf16_f32 v49, v82, v83
v_cvt_pk_bf16_f32 v50, v84, v85
v_cvt_pk_bf16_f32 v51, v86, v87
s_add_u32 s34, s33, 0
buffer_store_dwordx4 v[48:51], v4, s[20:23], s34 offen sc1
v_fma_f32 v88, v20, v115, v12
v_fma_f32 v89, v21, v115, v13
v_fma_f32 v90, v22, v115, v14
v_fma_f32 v91, v23, v115, v15
v_fma_f32 v88, v56, v114, v88
v_fma_f32 v89, v57, v114, v89
v_fma_f32 v90, v58, v114, v90
v_fma_f32 v91, v59, v114, v91
v_max_f32 v88, 0, v88
v_max_f32 v89, 0, v89
v_max_f32 v90, 0, v90
v_max_f32 v91, 0, v91
v_mul_f32 v88, v88, v88
v_mul_f32 v89, v89, v89
v_mul_f32 v90, v90, v90
v_mul_f32 v91, v91, v91
v_fma_f32 v92, v24, v115, v16
v_fma_f32 v93, v25, v115, v17
v_fma_f32 v94, v26, v115, v18
v_fma_f32 v95, v27, v115, v19
v_fma_f32 v92, v60, v114, v92
v_fma_f32 v93, v61, v114, v93
v_fma_f32 v94, v62, v114, v94
v_fma_f32 v95, v63, v114, v95
v_max_f32 v92, 0, v92
v_max_f32 v93, 0, v93
v_max_f32 v94, 0, v94
v_max_f32 v95, 0, v95
v_mul_f32 v92, v92, v92
v_mul_f32 v93, v93, v93
v_mul_f32 v94, v94, v94
v_mul_f32 v95, v95, v95
v_cvt_pk_bf16_f32 v56, v88, v89
v_cvt_pk_bf16_f32 v57, v90, v91
v_cvt_pk_bf16_f32 v58, v92, v93
v_cvt_pk_bf16_f32 v59, v94, v95
s_add_u32 s34, s33, 57344
buffer_store_dwordx4 v[56:59], v4, s[20:23], s34 offen sc1
v_fma_f32 v96, v20, v117, v12
v_fma_f32 v97, v21, v117, v13
v_fma_f32 v98, v22, v117, v14
v_fma_f32 v99, v23, v117, v15
v_fma_f32 v96, v64, v116, v96
v_fma_f32 v97, v65, v116, v97
v_fma_f32 v98, v66, v116, v98
v_fma_f32 v99, v67, v116, v99
v_max_f32 v96, 0, v96
v_max_f32 v97, 0, v97
v_max_f32 v98, 0, v98
v_max_f32 v99, 0, v99
v_mul_f32 v96, v96, v96
v_mul_f32 v97, v97, v97
v_mul_f32 v98, v98, v98
v_mul_f32 v99, v99, v99
v_fma_f32 v100, v24, v117, v16
v_fma_f32 v101, v25, v117, v17
v_fma_f32 v102, v26, v117, v18
v_fma_f32 v103, v27, v117, v19
v_fma_f32 v100, v68, v116, v100
v_fma_f32 v101, v69, v116, v101
v_fma_f32 v102, v70, v116, v102
v_fma_f32 v103, v71, v116, v103
v_max_f32 v100, 0, v100
v_max_f32 v101, 0, v101
v_max_f32 v102, 0, v102
v_max_f32 v103, 0, v103
v_mul_f32 v100, v100, v100
v_mul_f32 v101, v101, v101
v_mul_f32 v102, v102, v102
v_mul_f32 v103, v103, v103
v_cvt_pk_bf16_f32 v64, v96, v97
v_cvt_pk_bf16_f32 v65, v98, v99
v_cvt_pk_bf16_f32 v66, v100, v101
v_cvt_pk_bf16_f32 v67, v102, v103
s_add_u32 s34, s33, 114688
buffer_store_dwordx4 v[64:67], v4, s[20:23], s34 offen sc1
v_fma_f32 v104, v20, v119, v12
v_fma_f32 v105, v21, v119, v13
v_fma_f32 v106, v22, v119, v14
v_fma_f32 v107, v23, v119, v15
v_fma_f32 v104, v72, v118, v104
v_fma_f32 v105, v73, v118, v105
v_fma_f32 v106, v74, v118, v106
v_fma_f32 v107, v75, v118, v107
v_max_f32 v104, 0, v104
v_max_f32 v105, 0, v105
v_max_f32 v106, 0, v106
v_max_f32 v107, 0, v107
v_mul_f32 v104, v104, v104
v_mul_f32 v105, v105, v105
v_mul_f32 v106, v106, v106
v_mul_f32 v107, v107, v107
v_fma_f32 v108, v24, v119, v16
v_fma_f32 v109, v25, v119, v17
v_fma_f32 v110, v26, v119, v18
v_fma_f32 v111, v27, v119, v19
v_fma_f32 v108, v76, v118, v108
v_fma_f32 v109, v77, v118, v109
v_fma_f32 v110, v78, v118, v110
v_fma_f32 v111, v79, v118, v111
v_max_f32 v108, 0, v108
v_max_f32 v109, 0, v109
v_max_f32 v110, 0, v110
v_max_f32 v111, 0, v111
v_mul_f32 v108, v108, v108
v_mul_f32 v109, v109, v109
v_mul_f32 v110, v110, v110
v_mul_f32 v111, v111, v111
v_cvt_pk_bf16_f32 v72, v104, v105
v_cvt_pk_bf16_f32 v73, v106, v107
v_cvt_pk_bf16_f32 v74, v108, v109
v_cvt_pk_bf16_f32 v75, v110, v111
s_add_u32 s34, s33, 172032
buffer_store_dwordx4 v[72:75], v4, s[20:23], s34 offen sc1
s_mov_b32 s16, s96
s_and_b32 s17, s97, 0xffff
s_mov_b32 s18, 1835008
s_mov_b32 s19, 0x00020000
s_lshl_b32 s31, s24, 2
s_mul_i32 s31, s31, 57344
s_mul_i32 s32, s26, 7168
s_add_u32 s31, s31, s32
s_add_u32 s31, s31, 11534336
s_lshr_b32 s27, s26, 1
s_and_b32 s28, s26, 1
s_lshl_b32 s30, s24, 2
s_add_u32 s30, s30, s27
v_mul_u32_u24 v12, 896, v2
v_lshlrev_b32 v13, 5, v3
v_add_u32 v12, v12, v13
s_lshl_b32 s36, s25, 7
s_lshl_b32 s35, s28, 4
s_add_u32 s36, s36, s35
s_mul_i32 s34, s30, 14336
s_add_u32 s36, s36, s34
s_lshl_b32 s37, s26, 12
v_add_u32 v13, s37, v4
s_mov_b32 s94, s36
s_mov_b32 s95, s27
s_mov_b32 s98, s28
v_lshlrev_b32 v16, 16, v44
v_and_b32 v17, 0xffff0000, v44
v_lshlrev_b32 v24, 16, v8
v_and_b32 v25, 0xffff0000, v8
v_add_f32 v16, v16, v24
v_add_f32 v17, v17, v25
v_lshlrev_b32 v18, 16, v45
v_and_b32 v19, 0xffff0000, v45
v_lshlrev_b32 v24, 16, v9
v_and_b32 v25, 0xffff0000, v9
v_add_f32 v18, v18, v24
v_add_f32 v19, v19, v25
v_lshlrev_b32 v20, 16, v46
v_and_b32 v21, 0xffff0000, v46
v_lshlrev_b32 v24, 16, v10
v_and_b32 v25, 0xffff0000, v10
v_add_f32 v20, v20, v24
v_add_f32 v21, v21, v25
v_lshlrev_b32 v22, 16, v47
v_and_b32 v23, 0xffff0000, v47
v_lshlrev_b32 v24, 16, v11
v_and_b32 v25, 0xffff0000, v11
v_add_f32 v22, v22, v24
v_add_f32 v23, v23, v25
s_add_u32 s33, s25, 0
s_and_b32 s33, s33, 3
s_mul_i32 s80, s33, 57344
s_add_u32 s80, s80, s31
s_lshl_b32 s84, s33, 15
s_add_u32 s33, s25, 1
s_and_b32 s33, s33, 3
s_mul_i32 s81, s33, 57344
s_add_u32 s81, s81, s31
s_lshl_b32 s85, s33, 15
s_add_u32 s33, s25, 2
s_and_b32 s33, s33, 3
s_mul_i32 s82, s33, 57344
s_add_u32 s82, s82, s31
s_lshl_b32 s86, s33, 15
s_add_u32 s33, s25, 3
s_and_b32 s33, s33, 3
s_mul_i32 s83, s33, 57344
s_add_u32 s83, s83, s31
s_lshl_b32 s87, s33, 15
s_waitcnt vmcnt(0)
s_barrier
s_cmp_lg_u32 s26, 0
s_cbranch_scc1 WNP_P4
v_mov_b32 v6, s58
v_mov_b32 v7, s59
s_lshl_b32 s50, s24, 7
s_lshl_b32 s51, s25, 3
s_add_u32 s50, s50, s51
s_add_u32 s50, s50, 12288
v_mov_b32 v5, 0
s_mov_b64 exec, 1
s_cmp_eq_u32 s93, 1
s_cbranch_scc0 FS3_SC
buffer_store_dwordx2 v[6:7], v5, s[20:23], s50 offen
s_branch FS3_X
FS3_SC:
buffer_store_dwordx2 v[6:7], v5, s[20:23], s50 offen sc1
FS3_X:
s_mov_b64 exec, -1
WNP_P4:
s_mul_i32 s48, s25, 229376
s_mul_i32 s49, s26, 28672
s_add_u32 s48, s48, s49
s_add_u32 s48, s48, 21102592
s_add_u32 s45, s48, 20480
buffer_load_dwordx4 v[112:115], v4, s[20:23], s45 offen sc1
s_add_u32 s45, s48, 21504
buffer_load_dwordx4 v[116:119], v4, s[20:23], s45 offen sc1
s_add_u32 s45, s48, 22528
buffer_load_dwordx4 v[120:123], v4, s[20:23], s45 offen sc1
s_add_u32 s45, s48, 23552
buffer_load_dwordx4 v[124:127], v4, s[20:23], s45 offen sc1
s_add_u32 s45, s48, 24576
buffer_load_dwordx4 v[128:131], v4, s[20:23], s45 offen sc1
s_add_u32 s45, s48, 25600
buffer_load_dwordx4 v[132:135], v4, s[20:23], s45 offen sc1
s_add_u32 s45, s48, 26624
buffer_load_dwordx4 v[136:139], v4, s[20:23], s45 offen sc1
s_add_u32 s45, s48, 27648
buffer_load_dwordx4 v[140:143], v4, s[20:23], s45 offen sc1
s_cmp_lg_u32 s26, 0
s_cbranch_scc1 WNX_P4
s_lshl_b32 s50, s24, 7
s_add_u32 s50, s50, 12288
s_mov_b32 s52, 15
s_mov_b32 s53, 0
s_mov_b32 s51, 0
buffer_load_dwordx4 v[96:99], v4, s[20:23], s50 offen sc1
POLL_S4:
s_waitcnt vmcnt(0)
v_cmp_eq_u32 s[54:55], s58, v96
v_cmp_eq_u32 s[56:57], s59, v97
v_cmp_eq_u32 s[44:45], s58, v98
v_cmp_eq_u32 s[46:47], s59, v99
s_add_u32 s51, s51, 1
s_and_b64 s[54:55], s[54:55], s[56:57]
s_and_b64 s[44:45], s[44:45], s[46:47]
s_or_b64 s[44:45], s[44:45], 248
s_and_b64 s[54:55], s[54:55], s[44:45]
s_and_b64 s[54:55], s[54:55], s[52:53]
s_cmp_eq_u64 s[54:55], s[52:53]
s_cbranch_scc1 POLLX_S4
buffer_load_dwordx4 v[96:99], v4, s[20:23], s50 offen sc1
s_cmp_lt_u32 s51, 16384
s_cbranch_scc1 POLL_S4
POLLX_S4:
WNX_P4:
s_barrier
s_add_u32 s34, s80, 0
buffer_load_dwordx4 v[32:35], v4, s[20:23], s34 offen sc1
s_add_u32 s34, s80, 1024
buffer_load_dwordx4 v[36:39], v4, s[20:23], s34 offen sc1
s_add_u32 s34, s80, 2048
buffer_load_dwordx4 v[40:43], v4, s[20:23], s34 offen sc1
s_add_u32 s34, s80, 3072
buffer_load_dwordx4 v[44:47], v4, s[20:23], s34 offen sc1
s_add_u32 s34, s80, 4096
buffer_load_dwordx4 v[48:51], v4, s[20:23], s34 offen sc1
s_add_u32 s34, s80, 5120
buffer_load_dwordx4 v[52:55], v4, s[20:23], s34 offen sc1
s_add_u32 s34, s80, 6144
buffer_load_dwordx4 v[56:59], v4, s[20:23], s34 offen sc1
s_add_u32 s34, s81, 0
buffer_load_dwordx4 v[60:63], v4, s[20:23], s34 offen sc1
s_add_u32 s34, s81, 1024
buffer_load_dwordx4 v[64:67], v4, s[20:23], s34 offen sc1
s_add_u32 s34, s81, 2048
buffer_load_dwordx4 v[68:71], v4, s[20:23], s34 offen sc1
s_add_u32 s34, s81, 3072
buffer_load_dwordx4 v[72:75], v4, s[20:23], s34 offen sc1
s_add_u32 s34, s81, 4096
buffer_load_dwordx4 v[76:79], v4, s[20:23], s34 offen sc1
s_add_u32 s34, s81, 5120
buffer_load_dwordx4 v[80:83], v4, s[20:23], s34 offen sc1
s_add_u32 s34, s81, 6144
buffer_load_dwordx4 v[84:87], v4, s[20:23], s34 offen sc1
s_add_u32 s34, s82, 0
buffer_load_dwordx4 v[88:91], v4, s[20:23], s34 offen sc1
s_add_u32 s34, s82, 1024
buffer_load_dwordx4 v[92:95], v4, s[20:23], s34 offen sc1
v_mov_b32 v96, 0
v_mov_b32 v97, 0
v_mov_b32 v98, 0
v_mov_b32 v99, 0
v_mov_b32 v100, 0
v_mov_b32 v101, 0
v_mov_b32 v102, 0
v_mov_b32 v103, 0
v_mov_b32 v104, 0
v_mov_b32 v105, 0
v_mov_b32 v106, 0
v_mov_b32 v107, 0
v_mov_b32 v108, 0
v_mov_b32 v109, 0
v_mov_b32 v110, 0
v_mov_b32 v111, 0
s_waitcnt vmcnt(15)
v_mfma_f32_16x16x32_bf16 v[96:99], v[144:147], v[32:35], v[96:99]
v_mfma_f32_16x16x32_bf16 v[100:103], v[148:151], v[32:35], v[100:103]
v_mfma_f32_16x16x32_bf16 v[104:107], v[152:155], v[32:35], v[104:107]
v_mfma_f32_16x16x32_bf16 v[108:111], v[156:159], v[32:35], v[108:111]
s_add_u32 s34, s82, 2048
buffer_load_dwordx4 v[32:35], v4, s[20:23], s34 offen sc1
s_waitcnt vmcnt(15)
v_mfma_f32_16x16x32_bf16 v[96:99], v[160:163], v[36:39], v[96:99]
v_mfma_f32_16x16x32_bf16 v[100:103], v[164:167], v[36:39], v[100:103]
v_mfma_f32_16x16x32_bf16 v[104:107], v[168:171], v[36:39], v[104:107]
v_mfma_f32_16x16x32_bf16 v[108:111], v[172:175], v[36:39], v[108:111]
s_add_u32 s34, s82, 3072
buffer_load_dwordx4 v[36:39], v4, s[20:23], s34 offen sc1
s_waitcnt vmcnt(15)
v_mfma_f32_16x16x32_bf16 v[96:99], v[176:179], v[40:43], v[96:99]
v_mfma_f32_16x16x32_bf16 v[100:103], v[180:183], v[40:43], v[100:103]
v_mfma_f32_16x16x32_bf16 v[104:107], v[184:187], v[40:43], v[104:107]
v_mfma_f32_16x16x32_bf16 v[108:111], v[188:191], v[40:43], v[108:111]
s_add_u32 s34, s82, 4096
buffer_load_dwordx4 v[40:43], v4, s[20:23], s34 offen sc1
s_waitcnt vmcnt(15)
v_mfma_f32_16x16x32_bf16 v[96:99], v[192:195], v[44:47], v[96:99]
v_mfma_f32_16x16x32_bf16 v[100:103], v[196:199], v[44:47], v[100:103]
v_mfma_f32_16x16x32_bf16 v[104:107], v[200:203], v[44:47], v[104:107]
v_mfma_f32_16x16x32_bf16 v[108:111], v[204:207], v[44:47], v[108:111]
s_add_u32 s34, s82, 5120
buffer_load_dwordx4 v[44:47], v4, s[20:23], s34 offen sc1
s_waitcnt vmcnt(15)
v_mfma_f32_16x16x32_bf16 v[96:99], v[208:211], v[48:51], v[96:99]
v_mfma_f32_16x16x32_bf16 v[100:103], v[212:215], v[48:51], v[100:103]
v_mfma_f32_16x16x32_bf16 v[104:107], v[216:219], v[48:51], v[104:107]
v_mfma_f32_16x16x32_bf16 v[108:111], v[220:223], v[48:51], v[108:111]
s_add_u32 s34, s82, 6144
buffer_load_dwordx4 v[48:51], v4, s[20:23], s34 offen sc1
s_waitcnt vmcnt(15)
v_mfma_f32_16x16x32_bf16 v[96:99], v[112:115], v[52:55], v[96:99]
v_mfma_f32_16x16x32_bf16 v[100:103], v[116:119], v[52:55], v[100:103]
v_mfma_f32_16x16x32_bf16 v[104:107], v[120:123], v[52:55], v[104:107]
v_mfma_f32_16x16x32_bf16 v[108:111], v[124:127], v[52:55], v[108:111]
s_add_u32 s34, s83, 0
buffer_load_dwordx4 v[52:55], v4, s[20:23], s34 offen sc1
s_waitcnt vmcnt(15)
v_mfma_f32_16x16x32_bf16 v[96:99], v[128:131], v[56:59], v[96:99]
v_mfma_f32_16x16x32_bf16 v[100:103], v[132:135], v[56:59], v[100:103]
v_mfma_f32_16x16x32_bf16 v[104:107], v[136:139], v[56:59], v[104:107]
v_mfma_f32_16x16x32_bf16 v[108:111], v[140:143], v[56:59], v[108:111]
s_add_u32 s34, s83, 1024
buffer_load_dwordx4 v[56:59], v4, s[20:23], s34 offen sc1
v_add_u32 v14, s84, v13
s_nop 6
ds_write_b128 v14, v[96:99] offset:0
ds_write_b128 v14, v[100:103] offset:1024
ds_write_b128 v14, v[104:107] offset:2048
ds_write_b128 v14, v[108:111] offset:3072
v_mov_b32 v96, 0
v_mov_b32 v97, 0
v_mov_b32 v98, 0
v_mov_b32 v99, 0
v_mov_b32 v100, 0
v_mov_b32 v101, 0
v_mov_b32 v102, 0
v_mov_b32 v103, 0
v_mov_b32 v104, 0
v_mov_b32 v105, 0
v_mov_b32 v106, 0
v_mov_b32 v107, 0
v_mov_b32 v108, 0
v_mov_b32 v109, 0
v_mov_b32 v110, 0
v_mov_b32 v111, 0
s_waitcnt vmcnt(15)
v_mfma_f32_16x16x32_bf16 v[96:99], v[144:147], v[60:63], v[96:99]
v_mfma_f32_16x16x32_bf16 v[100:103], v[148:151], v[60:63], v[100:103]
v_mfma_f32_16x16x32_bf16 v[104:107], v[152:155], v[60:63], v[104:107]
v_mfma_f32_16x16x32_bf16 v[108:111], v[156:159], v[60:63], v[108:111]
s_add_u32 s34, s83, 2048
buffer_load_dwordx4 v[60:63], v4, s[20:23], s34 offen sc1
s_waitcnt vmcnt(15)
v_mfma_f32_16x16x32_bf16 v[96:99], v[160:163], v[64:67], v[96:99]
v_mfma_f32_16x16x32_bf16 v[100:103], v[164:167], v[64:67], v[100:103]
v_mfma_f32_16x16x32_bf16 v[104:107], v[168:171], v[64:67], v[104:107]
v_mfma_f32_16x16x32_bf16 v[108:111], v[172:175], v[64:67], v[108:111]
s_add_u32 s34, s83, 3072
buffer_load_dwordx4 v[64:67], v4, s[20:23], s34 offen sc1
s_waitcnt vmcnt(15)
v_mfma_f32_16x16x32_bf16 v[96:99], v[176:179], v[68:71], v[96:99]
v_mfma_f32_16x16x32_bf16 v[100:103], v[180:183], v[68:71], v[100:103]
v_mfma_f32_16x16x32_bf16 v[104:107], v[184:187], v[68:71], v[104:107]
v_mfma_f32_16x16x32_bf16 v[108:111], v[188:191], v[68:71], v[108:111]
s_add_u32 s34, s83, 4096
buffer_load_dwordx4 v[68:71], v4, s[20:23], s34 offen sc1
s_waitcnt vmcnt(15)
v_mfma_f32_16x16x32_bf16 v[96:99], v[192:195], v[72:75], v[96:99]
v_mfma_f32_16x16x32_bf16 v[100:103], v[196:199], v[72:75], v[100:103]
v_mfma_f32_16x16x32_bf16 v[104:107], v[200:203], v[72:75], v[104:107]
v_mfma_f32_16x16x32_bf16 v[108:111], v[204:207], v[72:75], v[108:111]
s_add_u32 s34, s83, 5120
buffer_load_dwordx4 v[72:75], v4, s[20:23], s34 offen sc1
s_waitcnt vmcnt(15)
v_mfma_f32_16x16x32_bf16 v[96:99], v[208:211], v[76:79], v[96:99]
v_mfma_f32_16x16x32_bf16 v[100:103], v[212:215], v[76:79], v[100:103]
v_mfma_f32_16x16x32_bf16 v[104:107], v[216:219], v[76:79], v[104:107]
v_mfma_f32_16x16x32_bf16 v[108:111], v[220:223], v[76:79], v[108:111]
s_add_u32 s34, s83, 6144
buffer_load_dwordx4 v[76:79], v4, s[20:23], s34 offen sc1
s_waitcnt vmcnt(15)
v_mfma_f32_16x16x32_bf16 v[96:99], v[112:115], v[80:83], v[96:99]
v_mfma_f32_16x16x32_bf16 v[100:103], v[116:119], v[80:83], v[100:103]
v_mfma_f32_16x16x32_bf16 v[104:107], v[120:123], v[80:83], v[104:107]
v_mfma_f32_16x16x32_bf16 v[108:111], v[124:127], v[80:83], v[108:111]
s_waitcnt vmcnt(14)
v_mfma_f32_16x16x32_bf16 v[96:99], v[128:131], v[84:87], v[96:99]
v_mfma_f32_16x16x32_bf16 v[100:103], v[132:135], v[84:87], v[100:103]
v_mfma_f32_16x16x32_bf16 v[104:107], v[136:139], v[84:87], v[104:107]
v_mfma_f32_16x16x32_bf16 v[108:111], v[140:143], v[84:87], v[108:111]
v_add_u32 v14, s85, v13
s_nop 6
ds_write_b128 v14, v[96:99] offset:0
ds_write_b128 v14, v[100:103] offset:1024
ds_write_b128 v14, v[104:107] offset:2048
ds_write_b128 v14, v[108:111] offset:3072
v_mov_b32 v96, 0
v_mov_b32 v97, 0
v_mov_b32 v98, 0
v_mov_b32 v99, 0
v_mov_b32 v100, 0
v_mov_b32 v101, 0
v_mov_b32 v102, 0
v_mov_b32 v103, 0
v_mov_b32 v104, 0
v_mov_b32 v105, 0
v_mov_b32 v106, 0
v_mov_b32 v107, 0
v_mov_b32 v108, 0
v_mov_b32 v109, 0
v_mov_b32 v110, 0
v_mov_b32 v111, 0
s_waitcnt vmcnt(13)
v_mfma_f32_16x16x32_bf16 v[96:99], v[144:147], v[88:91], v[96:99]
v_mfma_f32_16x16x32_bf16 v[100:103], v[148:151], v[88:91], v[100:103]
v_mfma_f32_16x16x32_bf16 v[104:107], v[152:155], v[88:91], v[104:107]
v_mfma_f32_16x16x32_bf16 v[108:111], v[156:159], v[88:91], v[108:111]
s_waitcnt vmcnt(12)
v_mfma_f32_16x16x32_bf16 v[96:99], v[160:163], v[92:95], v[96:99]
v_mfma_f32_16x16x32_bf16 v[100:103], v[164:167], v[92:95], v[100:103]
v_mfma_f32_16x16x32_bf16 v[104:107], v[168:171], v[92:95], v[104:107]
v_mfma_f32_16x16x32_bf16 v[108:111], v[172:175], v[92:95], v[108:111]
s_waitcnt vmcnt(11)
v_mfma_f32_16x16x32_bf16 v[96:99], v[176:179], v[32:35], v[96:99]
v_mfma_f32_16x16x32_bf16 v[100:103], v[180:183], v[32:35], v[100:103]
v_mfma_f32_16x16x32_bf16 v[104:107], v[184:187], v[32:35], v[104:107]
v_mfma_f32_16x16x32_bf16 v[108:111], v[188:191], v[32:35], v[108:111]
s_waitcnt vmcnt(10)
v_mfma_f32_16x16x32_bf16 v[96:99], v[192:195], v[36:39], v[96:99]
v_mfma_f32_16x16x32_bf16 v[100:103], v[196:199], v[36:39], v[100:103]
v_mfma_f32_16x16x32_bf16 v[104:107], v[200:203], v[36:39], v[104:107]
v_mfma_f32_16x16x32_bf16 v[108:111], v[204:207], v[36:39], v[108:111]
s_waitcnt vmcnt(9)
v_mfma_f32_16x16x32_bf16 v[96:99], v[208:211], v[40:43], v[96:99]
v_mfma_f32_16x16x32_bf16 v[100:103], v[212:215], v[40:43], v[100:103]
v_mfma_f32_16x16x32_bf16 v[104:107], v[216:219], v[40:43], v[104:107]
v_mfma_f32_16x16x32_bf16 v[108:111], v[220:223], v[40:43], v[108:111]
s_waitcnt vmcnt(8)
v_mfma_f32_16x16x32_bf16 v[96:99], v[112:115], v[44:47], v[96:99]
v_mfma_f32_16x16x32_bf16 v[100:103], v[116:119], v[44:47], v[100:103]
v_mfma_f32_16x16x32_bf16 v[104:107], v[120:123], v[44:47], v[104:107]
v_mfma_f32_16x16x32_bf16 v[108:111], v[124:127], v[44:47], v[108:111]
s_waitcnt vmcnt(7)
v_mfma_f32_16x16x32_bf16 v[96:99], v[128:131], v[48:51], v[96:99]
v_mfma_f32_16x16x32_bf16 v[100:103], v[132:135], v[48:51], v[100:103]
v_mfma_f32_16x16x32_bf16 v[104:107], v[136:139], v[48:51], v[104:107]
v_mfma_f32_16x16x32_bf16 v[108:111], v[140:143], v[48:51], v[108:111]
v_add_u32 v14, s86, v13
s_nop 6
ds_write_b128 v14, v[96:99] offset:0
ds_write_b128 v14, v[100:103] offset:1024
ds_write_b128 v14, v[104:107] offset:2048
ds_write_b128 v14, v[108:111] offset:3072
v_mov_b32 v96, 0
v_mov_b32 v97, 0
v_mov_b32 v98, 0
v_mov_b32 v99, 0
v_mov_b32 v100, 0
v_mov_b32 v101, 0
v_mov_b32 v102, 0
v_mov_b32 v103, 0
v_mov_b32 v104, 0
v_mov_b32 v105, 0
v_mov_b32 v106, 0
v_mov_b32 v107, 0
v_mov_b32 v108, 0
v_mov_b32 v109, 0
v_mov_b32 v110, 0
v_mov_b32 v111, 0
s_waitcnt vmcnt(6)
v_mfma_f32_16x16x32_bf16 v[96:99], v[144:147], v[52:55], v[96:99]
v_mfma_f32_16x16x32_bf16 v[100:103], v[148:151], v[52:55], v[100:103]
v_mfma_f32_16x16x32_bf16 v[104:107], v[152:155], v[52:55], v[104:107]
v_mfma_f32_16x16x32_bf16 v[108:111], v[156:159], v[52:55], v[108:111]
s_waitcnt vmcnt(5)
v_mfma_f32_16x16x32_bf16 v[96:99], v[160:163], v[56:59], v[96:99]
v_mfma_f32_16x16x32_bf16 v[100:103], v[164:167], v[56:59], v[100:103]
v_mfma_f32_16x16x32_bf16 v[104:107], v[168:171], v[56:59], v[104:107]
v_mfma_f32_16x16x32_bf16 v[108:111], v[172:175], v[56:59], v[108:111]
s_waitcnt vmcnt(4)
v_mfma_f32_16x16x32_bf16 v[96:99], v[176:179], v[60:63], v[96:99]
v_mfma_f32_16x16x32_bf16 v[100:103], v[180:183], v[60:63], v[100:103]
v_mfma_f32_16x16x32_bf16 v[104:107], v[184:187], v[60:63], v[104:107]
v_mfma_f32_16x16x32_bf16 v[108:111], v[188:191], v[60:63], v[108:111]
s_waitcnt vmcnt(3)
v_mfma_f32_16x16x32_bf16 v[96:99], v[192:195], v[64:67], v[96:99]
v_mfma_f32_16x16x32_bf16 v[100:103], v[196:199], v[64:67], v[100:103]
v_mfma_f32_16x16x32_bf16 v[104:107], v[200:203], v[64:67], v[104:107]
v_mfma_f32_16x16x32_bf16 v[108:111], v[204:207], v[64:67], v[108:111]
s_waitcnt vmcnt(2)
v_mfma_f32_16x16x32_bf16 v[96:99], v[208:211], v[68:71], v[96:99]
v_mfma_f32_16x16x32_bf16 v[100:103], v[212:215], v[68:71], v[100:103]
v_mfma_f32_16x16x32_bf16 v[104:107], v[216:219], v[68:71], v[104:107]
v_mfma_f32_16x16x32_bf16 v[108:111], v[220:223], v[68:71], v[108:111]
s_waitcnt vmcnt(1)
v_mfma_f32_16x16x32_bf16 v[96:99], v[112:115], v[72:75], v[96:99]
v_mfma_f32_16x16x32_bf16 v[100:103], v[116:119], v[72:75], v[100:103]
v_mfma_f32_16x16x32_bf16 v[104:107], v[120:123], v[72:75], v[104:107]
v_mfma_f32_16x16x32_bf16 v[108:111], v[124:127], v[72:75], v[108:111]
s_waitcnt vmcnt(0)
v_mfma_f32_16x16x32_bf16 v[96:99], v[128:131], v[76:79], v[96:99]
v_mfma_f32_16x16x32_bf16 v[100:103], v[132:135], v[76:79], v[100:103]
v_mfma_f32_16x16x32_bf16 v[104:107], v[136:139], v[76:79], v[104:107]
v_mfma_f32_16x16x32_bf16 v[108:111], v[140:143], v[76:79], v[108:111]
v_add_u32 v14, s87, v13
s_nop 6
ds_write_b128 v14, v[96:99] offset:0
ds_write_b128 v14, v[100:103] offset:1024
ds_write_b128 v14, v[104:107] offset:2048
ds_write_b128 v14, v[108:111] offset:3072
s_waitcnt lgkmcnt(0)
s_barrier
s_lshl_b32 s37, s95, 15
s_lshl_b32 s38, s98, 11
s_add_u32 s37, s37, s38
v_add_u32 v13, s37, v4
ds_read_b128 v[32:35], v13 offset:0
ds_read_b128 v[36:39], v13 offset:1024
ds_read_b128 v[40:43], v13 offset:4096
ds_read_b128 v[44:47], v13 offset:5120
ds_read_b128 v[48:51], v13 offset:8192
ds_read_b128 v[52:55], v13 offset:9216
ds_read_b128 v[56:59], v13 offset:12288
ds_read_b128 v[60:63], v13 offset:13312
ds_read_b128 v[64:67], v13 offset:16384
ds_read_b128 v[68:71], v13 offset:17408
ds_read_b128 v[72:75], v13 offset:20480
ds_read_b128 v[76:79], v13 offset:21504
ds_read_b128 v[80:83], v13 offset:24576
ds_read_b128 v[84:87], v13 offset:25600
s_waitcnt lgkmcnt(12)
ds_read_b128 v[88:91], v13 offset:28672
ds_read_b128 v[92:95], v13 offset:29696
s_waitcnt lgkmcnt(14)
v_add_f32 v16, v16, v32
v_add_f32 v17, v17, v33
v_add_f32 v18, v18, v34
v_add_f32 v19, v19, v35
v_add_f32 v20, v20, v36
v_add_f32 v21, v21, v37
v_add_f32 v22, v22, v38
v_add_f32 v23, v23, v39
s_waitcnt lgkmcnt(12)
v_add_f32 v16, v16, v40
v_add_f32 v17, v17, v41
v_add_f32 v18, v18, v42
v_add_f32 v19, v19, v43
v_add_f32 v20, v20, v44
v_add_f32 v21, v21, v45
v_add_f32 v22, v22, v46
v_add_f32 v23, v23, v47
s_waitcnt lgkmcnt(10)
v_add_f32 v16, v16, v48
v_add_f32 v17, v17, v49
v_add_f32 v18, v18, v50
v_add_f32 v19, v19, v51
v_add_f32 v20, v20, v52
v_add_f32 v21, v21, v53
v_add_f32 v22, v22, v54
v_add_f32 v23, v23, v55
s_waitcnt lgkmcnt(8)
v_add_f32 v16, v16, v56
v_add_f32 v17, v17, v57
v_add_f32 v18, v18, v58
v_add_f32 v19, v19, v59
v_add_f32 v20, v20, v60
v_add_f32 v21, v21, v61
v_add_f32 v22, v22, v62
v_add_f32 v23, v23, v63
s_waitcnt lgkmcnt(6)
v_add_f32 v16, v16, v64
v_add_f32 v17, v17, v65
v_add_f32 v18, v18, v66
v_add_f32 v19, v19, v67
v_add_f32 v20, v20, v68
v_add_f32 v21, v21, v69
v_add_f32 v22, v22, v70
v_add_f32 v23, v23, v71
s_waitcnt lgkmcnt(4)
v_add_f32 v16, v16, v72
v_add_f32 v17, v17, v73
v_add_f32 v18, v18, v74
v_add_f32 v19, v19, v75
v_add_f32 v20, v20, v76
v_add_f32 v21, v21, v77
v_add_f32 v22, v22, v78
v_add_f32 v23, v23, v79
s_waitcnt lgkmcnt(2)
v_add_f32 v16, v16, v80
v_add_f32 v17, v17, v81
v_add_f32 v18, v18, v82
v_add_f32 v19, v19, v83
v_add_f32 v20, v20, v84
v_add_f32 v21, v21, v85
v_add_f32 v22, v22, v86
v_add_f32 v23, v23, v87
s_waitcnt lgkmcnt(0)
v_add_f32 v16, v16, v88
v_add_f32 v17, v17, v89
v_add_f32 v18, v18, v90
v_add_f32 v19, v19, v91
v_add_f32 v20, v20, v92
v_add_f32 v21, v21, v93
v_add_f32 v22, v22, v94
v_add_f32 v23, v23, v95
v_cvt_pk_bf16_f32 v104, v16, v17
v_cvt_pk_bf16_f32 v105, v18, v19
v_cvt_pk_bf16_f32 v106, v20, v21
v_cvt_pk_bf16_f32 v107, v22, v23
buffer_store_dwordx4 v[104:107], v12, s[16:19], s94 offen
s_branch K_FIN
K_J7:
s_load_dwordx2 s[30:31], s[0:1], 16
s_load_dwordx2 s[32:33], s[0:1], 32
s_load_dwordx2 s[34:35], s[0:1], 48
s_waitcnt vmcnt(0)
s_barrier
s_cmp_lg_u32 s26, 0
s_cbranch_scc1 K_J7B
v_mov_b32 v6, s58
v_mov_b32 v7, s59
s_lshl_b32 s50, s24, 7
s_lshl_b32 s51, s25, 4
s_add_u32 s50, s50, s51
s_add_u32 s50, s50, 4096
v_mov_b32 v5, 0
v_mov_b32 v8, s99
v_mov_b32 v9, s99
s_mov_b64 exec, 1
buffer_store_dwordx4 v[6:9], v5, s[20:23], s50 offen sc1
s_mov_b64 exec, -1
K_J7B:
s_waitcnt lgkmcnt(0)
s_mov_b32 s28, 1
s_branch RL_ENTRY
K_FIN:
K_END:
s_endpgm
K_CODE_END:
.section .rodata,"a"
.p2align 6
.amdhsa_kernel sequential_preLN__sliding_block__dense_activation_squared_relu__prompt_kernel
  .amdhsa_next_free_vgpr 256
  .amdhsa_next_free_sgpr 100
  .amdhsa_accum_offset 256
  .amdhsa_group_segment_fixed_size 0
  .amdhsa_kernarg_size 88
  .amdhsa_user_sgpr_count 2
  .amdhsa_user_sgpr_kernarg_segment_ptr 1
  .amdhsa_system_sgpr_workgroup_id_x 1
.end_amdhsa_kernel
```
